```python
import torch

def _softmax(x, axis=-1):
    return torch.softmax(x, dim=axis)
def _gelu(x):
    return torch.nn.functional.gelu(x, approximate="tanh")
def _silu(x):
    return torch.nn.functional.silu(x)
def _sigmoid(x):
    return torch.sigmoid(x)
def _layernorm(x, axis=-1, eps=1e-5):
    m = x.mean(dim=axis, keepdim=True)
    v = x.var(dim=axis, keepdim=True, unbiased=False)
    return (x - m) / torch.sqrt(v + eps)
def _scatter_add(tgt, idx, src, axis=0):
    return tgt.clone().index_add_(axis, idx, src)
def _segment_sum(src, seg, n):
    out = torch.zeros((n,) + src.shape[1:], dtype=src.dtype)
    return out.index_add_(0, seg, src)
def _pad(x, pw):
    flat = tuple(v for pair in reversed(pw) for v in pair)
    return torch.nn.functional.pad(x, flat)

kernel_name = 'gated_mix__grouped_kv_mqa__sliding_local_dilated__prompt'

def setup_inputs():

    _w = (lambda a: (lambda t: t.to(torch.bfloat16) if t.is_floating_point() else t)(torch.as_tensor(a)))
    def _A_setup():
        B, S, D, H = 1, 2048, 640, 32
        Dh = D // H
        return {
            "x": _w((lambda *s: torch.randn(*s, dtype=torch.bfloat16) * 0.05)(B, S, D)),
            "wq": _w((lambda *s: torch.randn(*s, dtype=torch.bfloat16) * 1.6)(D, H * Dh)),
            "wk": _w((lambda *s: torch.randn(*s, dtype=torch.bfloat16) * 1.6)(D, Dh)),
            "wv": _w((lambda *s: torch.randn(*s, dtype=torch.bfloat16) * 0.2)(D, Dh)),
            "wo": _w((lambda *s: torch.randn(*s, dtype=torch.bfloat16) * 0.2)(H * Dh, D)),
        }
    _A_in = _A_setup()

    def _B_setup():
        B, S, D = 1, 2048, 640
        return {
            "x": _w((lambda *s: torch.randn(*s, dtype=torch.bfloat16) * 0.05)(B, S, D)),
            "wqkv": _w((lambda *s: torch.randn(*s, dtype=torch.bfloat16) * 0.8)(D, 3 * D)),
            "wo": _w((lambda *s: torch.randn(*s, dtype=torch.bfloat16) * 0.05)(D, D)),
        }
    _B_in = _B_setup()

    return {
        "A_x": _A_in["x"],
        "A_wq": _A_in["wq"],
        "A_wk": _A_in["wk"],
        "A_wv": _A_in["wv"],
        "A_wo": _A_in["wo"],
        "B_x": _B_in["x"],
        "B_wqkv": _B_in["wqkv"],
        "B_wo": _B_in["wo"],
        "gate_w": _w((lambda *s: torch.randn(*s, dtype=torch.bfloat16) * 0.05)(640) * 16.0),
    }

def reference(A_x, A_wq, A_wk, A_wv, A_wo, B_x, B_wqkv, B_wo, gate_w):
    def _A_ref(x, wq, wk, wv, wo):
        B, S, D = x.shape
        H = 32
        Dh = D // H
        q = (lambda x, *d: x.permute(*d))((x @ wq).reshape(B, S, H, Dh), 0, 2, 1, 3)
        k = x @ wk
        v = x @ wv
        scores = torch.einsum("bhqd,bkd->bhqk", q, k) * (Dh ** -0.5)
        p = _softmax(scores, axis=-1)
        o = torch.einsum("bhqk,bkd->bhqd", p, v)
        return (lambda x, *d: x.permute(*d))(o, 0, 2, 1, 3).reshape(B, S, H * Dh) @ wo

    def _B_ref(x, wqkv, wo):
        B, S, D = x.shape
        H = 32; Dh = D // H
        W, dil = 8, 2
        qkv = (lambda x, *d: x.permute(*d))((x @ wqkv).reshape(B, S, 3, H, Dh), 2, 0, 3, 1, 4)
        q, k, v = qkv[0], qkv[1], qkv[2]
        scale = Dh ** -0.5
        pos = torch.arange(S)
        off = torch.arange(W) * dil
        idx = pos[:, None] - off[None, :]
        mask = idx >= 0
        idx_c = torch.where(mask, idx, 0).reshape(-1)
        kg = k[:, :, idx_c, :].reshape(B, H, S, W, Dh)
        vg = v[:, :, idx_c, :].reshape(B, H, S, W, Dh)
        logits = torch.einsum("bhsd,bhswd->bhsw", q, kg) * scale
        logits = torch.where(mask[None, None, :, :], logits, -1e9)
        attn = _softmax(logits, axis=-1)
        o = torch.einsum("bhsw,bhswd->bhsd", attn, vg)
        return (lambda x, *d: x.permute(*d))(o, 0, 2, 1, 3).reshape(B, S, D) @ wo

    x = A_x
    g = _sigmoid((x * gate_w).sum(-1, keepdims=True))
    a = _A_ref(x, A_wq, A_wk, A_wv, A_wo)
    b = _B_ref(x, B_wqkv, B_wo)
    return g * a + (1 - g) * b
```

```asm
; @launch grid=(256,1,1) block=(768,1,1) lds=163840
.amdgcn_target "amdgcn-amd-amdhsa--gfx950"
.text
.globl gated_mix__grouped_kv_mqa__sliding_local_dilated__prompt_kernel
.p2align 8
.type gated_mix__grouped_kv_mqa__sliding_local_dilated__prompt_kernel,@function
gated_mix__grouped_kv_mqa__sliding_local_dilated__prompt_kernel:
    s_cmp_ge_u32 s2, 256
    s_cbranch_scc1 F_END
    s_load_dwordx16 s[4:19], s[0:1], 0
    s_load_dwordx8 s[20:27], s[0:1], 64
    v_lshrrev_b32 v1, 6, v0
    v_and_b32 v0, 63, v0
    v_readfirstlane_b32 s44, v1
    s_and_b32 s47, s2, 6
    s_lshr_b32 s48, s2, 5
    s_lshl2_add_u32 s45, s47, s48
    s_and_b32 s47, s2, 1
    s_bfe_u32 s48, s2, 0x20003
    s_lshl2_add_u32 s46, s47, s48
    s_cmp_lt_u32 s44, 8
    s_cbranch_scc1 F_COMP
    s_sub_u32 s53, s44, 8
    s_lshl1_add_u32 s63, s48, s47
    v_lshlrev_b32 v7, 4, v0
    s_sub_u32 s49, s53, 1
    s_cmp_lt_u32 s49, 2
    s_cbranch_scc1 F_LW
    v_lshrrev_b32 v1, 3, v0
    v_mul_u32_u24 v1, 2560, v1
    s_mul_i32 s47, s45, 81920
    v_lshrrev_b32 v2, 4, v0
    v_xor_b32 v2, v2, v0
    v_and_b32 v2, 7, v2
    v_add_u32 v1, s47, v1
    v_lshl_add_u32 v24, v2, 4, v1
    v_xor_b32 v25, 64, v24
    v_add_u32 v25, 19456, v25
    s_lshr_b32 s47, s63, 1
    s_cmp_eq_u32 s53, 0
    s_cbranch_scc1 F_L0
    s_memrealtime s[56:57]
    v_add_u32 v1, s2, v0
    v_lshlrev_b32 v1, 8, v1
    s_lshl_b32 s58, s47, 11
    s_add_u32 s58, s58, 512
    s_and_b32 s59, s47, 1
    s_lshl_b32 s59, s59, 5
    s_lshr_b32 s52, s47, 1
    s_add_u32 s59, s59, s52
    s_mulk_i32 s59, 1280
    s_mov_b32 s49, 0
    s_mov_b32 s50, s59
    s_waitcnt lgkmcnt(0)
    s_mov_b32 s36, s24
    s_and_b32 s37, s25, 0xffff
    s_mov_b32 s38, 256
    s_mov_b32 s39, 0x00020000
    s_or_b32 s56, s56, 1
    v_mov_b32 v2, s56
    buffer_store_dword v2, v1, s[36:39], 0 offen sc1
    s_mov_b32 s28, s4
    s_and_b32 s29, s5, 0xffff
    s_mov_b32 s30, 2621440
    s_mov_b32 s31, 0x00020000
    s_bitcmp1_b32 s63, 0
    s_cselect_b32 s32, s10, s8
    s_cselect_b32 s33, s11, s9
    s_and_b32 s33, s33, 0xffff
    s_mov_b32 s34, 25600
    s_mov_b32 s35, 0x00020000
    s_mov_b32 s51, s58
F_EIS:
    s_add_u32 m0, s49, 133632
    s_add_u32 s48, s49, 4096
    buffer_load_dwordx4 v7, s[32:35], s49 offen lds
    buffer_load_dwordx4 v7, s[32:35], s49 offen offset:1024 lds
    buffer_load_dwordx4 v7, s[32:35], s49 offen offset:2048 lds
    buffer_load_dwordx4 v7, s[32:35], s49 offen offset:3072 lds
    s_add_u32 m0, s49, 137728
    s_add_u32 s49, s49, 5120
    buffer_load_dwordx4 v7, s[32:35], s48 offen lds
    s_mov_b32 m0, s51
    s_add_u32 s48, s50, 128
    buffer_load_dwordx4 v24, s[28:31], s50 offen lds
    buffer_load_dwordx4 v25, s[28:31], s50 offen offset:1024 lds
    s_add_u32 m0, s51, 8192
    s_add_u32 s50, s50, 256
    buffer_load_dwordx4 v24, s[28:31], s48 offen lds
    buffer_load_dwordx4 v25, s[28:31], s48 offen offset:1024 lds
    s_add_u32 s51, s51, 16384
    s_cmp_lt_u32 s49, 25600
    s_cbranch_scc1 F_EIS
    s_barrier
    s_mov_b32 s40, s26
    s_and_b32 s41, s27, 0xffff
    s_mov_b32 s42, 11534336
    s_mov_b32 s43, 0x00020000
    v_and_b32 v1, 15, v0
    v_lshrrev_b32 v2, 4, v0
    v_lshrrev_b32 v3, 1, v1
    v_xor_b32 v3, v3, v2
    v_lshlrev_b32 v1, 7, v1
    v_add_u32 v1, s58, v1
    v_lshl_add_u32 v8, v3, 4, v1
    v_xor_b32 v9, 64, v8
    v_bfe_u32 v1, v0, 2, 2
    v_lshl_add_u32 v1, v2, 3, v1
    v_mul_u32_u24 v1, 40, v1
    v_add_u32 v1, 133632, v1
    v_and_b32 v2, 3, v0
    s_lshr_b32 s47, s63, 2
    s_lshl_b32 s61, s45, 1
    s_add_u32 s61, s61, s47
    s_mul_i32 s61, s61, 3072
    s_bfe_u32 s51, s63, 0x10001
    s_bitcmp1_b32 s63, 0
    s_cbranch_scc1 F_EV
    v_min_u32 v3, 1, v2
    v_lshl_add_u32 v11, v3, 3, v1
    v_add_u32 v11, 16, v11
    v_lshl_add_u32 v10, v2, 3, v1
    s_mov_b32 exec_lo, 0xcccccccc
    s_mov_b32 exec_hi, 0xcccccccc
    v_add_u32 v10, 32, v1
    s_mov_b64 exec, -1
    v_and_b32 v1, 15, v0
    v_lshrrev_b32 v2, 4, v0
    v_lshlrev_b32 v73, 3, v1
    v_lshlrev_b32 v1, 4, v1
    v_lshl_add_u32 v72, v2, 9, v1
    s_lshl_b32 s47, s51, 8
    s_add_u32 s47, s47, s61
    s_lshl_b32 s48, s51, 7
    s_add_u32 s48, s48, s61
    s_mov_b32 s49, 0x3ea52b5c
    v_mov_b32 v60, 0
    v_mov_b32 v61, 0
    v_mov_b32 v62, 0
    v_mov_b32 v63, 0
    v_mov_b32 v64, 0
    v_mov_b32 v65, 0
    v_mov_b32 v66, 0
    v_mov_b32 v67, 0
    s_mov_b32 s50, 0
    s_waitcnt vmcnt(36)
F_EKL:
    ds_read_b128 v[12:15], v8
    ds_read_b64_tr_b16 v[28:29], v10 offset:0
    ds_read_b64_tr_b16 v[30:31], v10 offset:160
    ds_read_b64_tr_b16 v[32:33], v11 offset:0
    ds_read_b64_tr_b16 v[34:35], v11 offset:160
    ds_read_b128 v[16:19], v9
    ds_read_b64_tr_b16 v[36:37], v10 offset:1280
    ds_read_b64_tr_b16 v[38:39], v10 offset:1440
    ds_read_b64_tr_b16 v[40:41], v11 offset:1280
    ds_read_b64_tr_b16 v[42:43], v11 offset:1440
    ds_read_b128 v[20:23], v8 offset:8192
    ds_read_b64_tr_b16 v[44:45], v10 offset:2560
    ds_read_b64_tr_b16 v[46:47], v10 offset:2720
    ds_read_b64_tr_b16 v[48:49], v11 offset:2560
    ds_read_b64_tr_b16 v[50:51], v11 offset:2720
    ds_read_b128 v[24:27], v9 offset:8192
    ds_read_b64_tr_b16 v[52:53], v10 offset:3840
    ds_read_b64_tr_b16 v[54:55], v10 offset:4000
    ds_read_b64_tr_b16 v[56:57], v11 offset:3840
    ds_read_b64_tr_b16 v[58:59], v11 offset:4000
    v_add_u32 v8, 16384, v8
    v_add_u32 v10, 5120, v10
    v_add_u32 v9, 16384, v9
    v_add_u32 v11, 5120, v11
    s_add_u32 s50, s50, 1
    s_waitcnt lgkmcnt(15)
    v_mfma_f32_16x16x32_bf16 v[60:63], v[28:31], v[12:15], v[60:63]
    v_mfma_f32_16x16x32_bf16 v[64:67], v[32:35], v[12:15], v[64:67]
    s_waitcnt lgkmcnt(10)
    v_mfma_f32_16x16x32_bf16 v[60:63], v[36:39], v[16:19], v[60:63]
    v_mfma_f32_16x16x32_bf16 v[64:67], v[40:43], v[16:19], v[64:67]
    s_waitcnt lgkmcnt(5)
    v_mfma_f32_16x16x32_bf16 v[60:63], v[44:47], v[20:23], v[60:63]
    v_mfma_f32_16x16x32_bf16 v[64:67], v[48:51], v[20:23], v[64:67]
    s_waitcnt lgkmcnt(0)
    v_mfma_f32_16x16x32_bf16 v[60:63], v[52:55], v[24:27], v[60:63]
    v_mfma_f32_16x16x32_bf16 v[64:67], v[56:59], v[24:27], v[64:67]
    s_waitcnt vmcnt(27)
    s_cmp_eq_u32 s50, 1
    s_cbranch_scc1 F_EKL
    s_waitcnt vmcnt(18)
    s_cmp_eq_u32 s50, 2
    s_cbranch_scc1 F_EKL
    s_waitcnt vmcnt(9)
    s_cmp_eq_u32 s50, 3
    s_cbranch_scc1 F_EKL
    s_waitcnt vmcnt(0)
    s_cmp_eq_u32 s50, 4
    s_cbranch_scc1 F_EKL
    v_mul_f32 v60, s49, v60
    v_mul_f32 v61, s49, v61
    v_mul_f32 v62, s49, v62
    v_mul_f32 v63, s49, v63
    v_mul_f32 v64, s49, v64
    v_mul_f32 v65, s49, v65
    v_mul_f32 v66, s49, v66
    v_mul_f32 v67, s49, v67
    v_cvt_pk_bf16_f32 v68, v60, v61
    v_cvt_pk_bf16_f32 v69, v62, v63
    v_cvt_pk_bf16_f32 v70, v64, v65
    v_cvt_pk_bf16_f32 v71, v66, v67
    s_mov_b32 exec_lo, 0xffffffff
    s_mov_b32 exec_hi, 0x0
    buffer_store_dwordx4 v[68:71], v72, s[40:43], s47 offen sc1
    s_mov_b32 exec_lo, 0x0
    s_mov_b32 exec_hi, 0xffff
    buffer_store_dwordx2 v[68:69], v73, s[40:43], s48 offen offset:2560 sc1
    s_mov_b64 exec, -1
    s_branch F_E_DONE
F_EV:
    v_lshl_add_u32 v10, v2, 3, v1
    v_add_u32 v11, 32, v1
    v_and_b32 v1, 15, v0
    v_bfe_u32 v2, v0, 4, 1
    v_mul_u32_u24 v2, 21, v2
    v_add_u32 v1, v1, v2
    v_lshrrev_b32 v2, 5, v0
    v_lshl_add_u32 v1, v2, 4, v1
    v_lshlrev_b32 v72, 4, v1
    s_mul_i32 s47, s51, 768
    s_add_u32 s47, s47, s61
    v_mov_b32 v60, 0
    v_mov_b32 v61, 0
    v_mov_b32 v62, 0
    v_mov_b32 v63, 0
    v_mov_b32 v64, 0
    v_mov_b32 v65, 0
    v_mov_b32 v66, 0
    v_mov_b32 v67, 0
    s_mov_b32 s50, 0
    s_waitcnt vmcnt(36)
F_EVL:
    ds_read_b128 v[12:15], v8
    ds_read_b64_tr_b16 v[28:29], v10 offset:0
    ds_read_b64_tr_b16 v[30:31], v10 offset:160
    ds_read_b64_tr_b16 v[32:33], v11 offset:0
    ds_read_b64_tr_b16 v[34:35], v11 offset:160
    ds_read_b128 v[16:19], v9
    ds_read_b64_tr_b16 v[36:37], v10 offset:1280
    ds_read_b64_tr_b16 v[38:39], v10 offset:1440
    ds_read_b64_tr_b16 v[40:41], v11 offset:1280
    ds_read_b64_tr_b16 v[42:43], v11 offset:1440
    ds_read_b128 v[20:23], v8 offset:8192
    ds_read_b64_tr_b16 v[44:45], v10 offset:2560
    ds_read_b64_tr_b16 v[46:47], v10 offset:2720
    ds_read_b64_tr_b16 v[48:49], v11 offset:2560
    ds_read_b64_tr_b16 v[50:51], v11 offset:2720
    ds_read_b128 v[24:27], v9 offset:8192
    ds_read_b64_tr_b16 v[52:53], v10 offset:3840
    ds_read_b64_tr_b16 v[54:55], v10 offset:4000
    ds_read_b64_tr_b16 v[56:57], v11 offset:3840
    ds_read_b64_tr_b16 v[58:59], v11 offset:4000
    v_add_u32 v8, 16384, v8
    v_add_u32 v10, 5120, v10
    v_add_u32 v9, 16384, v9
    v_add_u32 v11, 5120, v11
    s_add_u32 s50, s50, 1
    s_waitcnt lgkmcnt(15)
    v_mfma_f32_16x16x32_bf16 v[60:63], v[12:15], v[28:31], v[60:63]
    v_mfma_f32_16x16x32_bf16 v[64:67], v[12:15], v[32:35], v[64:67]
    s_waitcnt lgkmcnt(10)
    v_mfma_f32_16x16x32_bf16 v[60:63], v[16:19], v[36:39], v[60:63]
    v_mfma_f32_16x16x32_bf16 v[64:67], v[16:19], v[40:43], v[64:67]
    s_waitcnt lgkmcnt(5)
    v_mfma_f32_16x16x32_bf16 v[60:63], v[20:23], v[44:47], v[60:63]
    v_mfma_f32_16x16x32_bf16 v[64:67], v[20:23], v[48:51], v[64:67]
    s_waitcnt lgkmcnt(0)
    v_mfma_f32_16x16x32_bf16 v[60:63], v[24:27], v[52:55], v[60:63]
    v_mfma_f32_16x16x32_bf16 v[64:67], v[24:27], v[56:59], v[64:67]
    s_waitcnt vmcnt(27)
    s_cmp_eq_u32 s50, 1
    s_cbranch_scc1 F_EVL
    s_waitcnt vmcnt(18)
    s_cmp_eq_u32 s50, 2
    s_cbranch_scc1 F_EVL
    s_waitcnt vmcnt(9)
    s_cmp_eq_u32 s50, 3
    s_cbranch_scc1 F_EVL
    s_waitcnt vmcnt(0)
    s_cmp_eq_u32 s50, 4
    s_cbranch_scc1 F_EVL
    v_cvt_pk_bf16_f32 v68, v60, v61
    v_cvt_pk_bf16_f32 v69, v62, v63
    v_cvt_pk_bf16_f32 v70, v64, v65
    v_cvt_pk_bf16_f32 v71, v66, v67
    s_nop 1
    v_permlane32_swap_b32 v68, v70
    v_permlane32_swap_b32 v69, v71
    s_mov_b32 exec_lo, 0x0
    s_mov_b32 exec_hi, 0x100010
    v_mov_b32 v68, 0x3f803f80
    v_mov_b32 v69, 0x3f803f80
    v_mov_b32 v70, 0x3f803f80
    v_mov_b32 v71, 0x3f803f80
    s_mov_b32 exec_lo, 0xffffffff
    s_mov_b32 exec_hi, 0x1f001f
    buffer_store_dwordx4 v[68:71], v72, s[40:43], s47 offen offset:1024 sc1
    s_mov_b64 exec, -1
F_E_DONE:
    v_mov_b32 v22, 0
    buffer_load_dword v21, v22, s[36:39], 0 offen sc1
    s_barrier
    s_mov_b32 s48, 0
    s_mov_b32 s36, s24
    s_and_b32 s37, s25, 0xffff
    s_mov_b32 s38, 256
    s_mov_b32 s39, 0x00020000
    v_mov_b32 v22, 0
F_E_TAG:
    s_waitcnt vmcnt(0)
    v_readfirstlane_b32 s55, v21
    s_add_u32 s48, s48, 1
    s_cmp_ge_u32 s48, 65536
    s_cbranch_scc1 F_E_TAGOK
    s_cmp_lg_u32 s55, 0
    s_cbranch_scc1 F_E_TAGOK
    buffer_load_dword v21, v22, s[36:39], 0 offen sc1
    s_branch F_E_TAG
F_E_TAGOK:
    s_lshl_b32 s47, s2, 6
    s_add_u32 s47, s47, 262144
    s_mov_b64 exec, 1
    buffer_store_dword v21, v22, s[40:43], s47 offen sc1
    s_mov_b64 exec, -1
    s_barrier
    s_branch F_PREP
F_L0:
    s_waitcnt lgkmcnt(0)
    s_mov_b32 s28, s4
    s_and_b32 s29, s5, 0xffff
    s_mov_b32 s30, 2621440
    s_mov_b32 s31, 0x00020000
    s_add_u32 s48, s47, 1
    s_and_b32 s48, s48, 3
    s_lshl_b32 s4, s48, 11
    s_add_u32 s4, s4, 512
    s_and_b32 s7, s48, 1
    s_lshl_b32 s7, s7, 5
    s_lshr_b32 s52, s48, 1
    s_add_u32 s7, s7, s52
    s_mulk_i32 s7, 1280
    s_add_u32 s48, s47, 2
    s_and_b32 s48, s48, 3
    s_lshl_b32 s5, s48, 11
    s_add_u32 s5, s5, 512
    s_and_b32 s8, s48, 1
    s_lshl_b32 s8, s8, 5
    s_lshr_b32 s52, s48, 1
    s_add_u32 s8, s8, s52
    s_mulk_i32 s8, 1280
    v_mov_b32 v26, v24
    v_mov_b32 v27, v25
    s_add_u32 s48, s47, 3
    s_and_b32 s48, s48, 3
    s_lshl_b32 s6, s48, 11
    s_add_u32 s6, s6, 512
    s_and_b32 s9, s48, 1
    s_lshl_b32 s9, s9, 5
    s_lshr_b32 s52, s48, 1
    s_add_u32 s9, s9, s52
    s_mulk_i32 s9, 1280
    v_mov_b32 v28, v24
    v_mov_b32 v29, v25
    s_mov_b32 s14, 8192
    s_mov_b32 s15, 81920
    s_mov_b32 s16, 128
    s_branch F_LGO
F_LW:
    s_mul_i32 s50, s46, 160
    s_mul_i32 s51, s49, 320
    v_add_u32 v1, s51, v0
    v_mul_u32_u24 v2, 6554, v1
    v_lshrrev_b32 v2, 16, v2
    v_mul_u32_u24 v2, 1120, v2
    v_lshl_add_u32 v2, v1, 4, v2
    v_add_u32 v24, s50, v2
    v_add_u32 v1, s51, v0
    v_add_u32 v1, 64, v1
    v_mul_u32_u24 v2, 6554, v1
    v_lshrrev_b32 v2, 16, v2
    v_mul_u32_u24 v2, 1120, v2
    v_lshl_add_u32 v2, v1, 4, v2
    v_add_u32 v25, s50, v2
    v_subrev_u32 v25, 1024, v25
    v_add_u32 v1, s51, v0
    v_add_u32 v1, 128, v1
    v_mul_u32_u24 v2, 6554, v1
    v_lshrrev_b32 v2, 16, v2
    v_mul_u32_u24 v2, 1120, v2
    v_lshl_add_u32 v2, v1, 4, v2
    v_add_u32 v26, s50, v2
    v_add_u32 v1, s51, v0
    v_add_u32 v1, 192, v1
    v_mul_u32_u24 v2, 6554, v1
    v_lshrrev_b32 v2, 16, v2
    v_mul_u32_u24 v2, 1120, v2
    v_lshl_add_u32 v2, v1, 4, v2
    v_add_u32 v27, s50, v2
    v_subrev_u32 v27, 1024, v27
    v_add_u32 v1, s51, v0
    v_add_u32 v1, 256, v1
    v_mul_u32_u24 v2, 6554, v1
    v_lshrrev_b32 v2, 16, v2
    v_mul_u32_u24 v2, 1120, v2
    v_lshl_add_u32 v2, v1, 4, v2
    v_add_u32 v28, s50, v2
    v_mov_b32 v29, 0
    s_waitcnt lgkmcnt(0)
    s_mov_b32 s28, s6
    s_and_b32 s29, s7, 0xffff
    s_mov_b32 s30, 819200
    s_mov_b32 s31, 0x00020000
    s_mul_i32 s49, s49, 5120
    s_add_u32 s4, s49, 82432
    s_mov_b32 s7, 0
    s_add_u32 s5, s49, 84480
    s_mov_b32 s8, 0
    s_add_u32 s6, s49, 86528
    s_mov_b32 s9, 0
    s_mov_b32 s14, 10240
    s_mov_b32 s15, 71680
    s_mov_b32 s16, 81920
F_LGO:
    s_mov_b32 s10, 0
    s_mov_b32 s11, 0
    s_mov_b32 s40, s26
    s_and_b32 s41, s27, 0xffff
    s_mov_b32 s42, 11534336
    s_mov_b32 s43, 0x00020000
    s_barrier
    s_add_u32 m0, s4, s10
    s_add_u32 s48, s7, s11
    buffer_load_dwordx4 v24, s[28:31], s48 offen lds
    buffer_load_dwordx4 v25, s[28:31], s48 offen offset:1024 lds
    s_add_u32 m0, s5, s10
    s_add_u32 s48, s8, s11
    buffer_load_dwordx4 v26, s[28:31], s48 offen lds
    buffer_load_dwordx4 v27, s[28:31], s48 offen offset:1024 lds
    s_add_u32 m0, s6, s10
    s_add_u32 s48, s9, s11
    buffer_load_dwordx4 v28, s[28:31], s48 offen lds
    s_cmp_lg_u32 s53, 0
    s_cbranch_scc1 F_IS1
    buffer_load_dwordx4 v29, s[28:31], s48 offen offset:1024 lds
F_IS1:
    s_add_u32 s10, s10, s14
    s_cmp_eq_u32 s10, s15
    s_cselect_b32 s10, 0, s10
    s_add_u32 s11, s11, s16
    s_branch F_PREP
F_COMP:
    s_lshl_b32 s47, s44, 6
    v_add_u32 v1, s47, v0
    v_mul_u32_u24 v2, 2185, v1
    v_lshrrev_b32 v2, 16, v2
    v_mul_u32_u24 v3, 30, v2
    v_cmp_gt_u32 vcc, 480, v1
    v_sub_u32 v1, v1, v3
    v_mul_u32_u24 v3, 205, v1
    v_lshrrev_b32 v3, 11, v3
    v_mul_u32_u24 v2, 3840, v2
    v_mul_u32_u24 v3, 1120, v3
    v_add_u32 v2, v2, v3
    v_lshl_add_u32 v2, v1, 4, v2
    v_mov_b32 v1, 1073741824
    v_cndmask_b32 v4, v1, v2, vcc
    s_lshr_b32 s60, s2, 3
    s_and_b32 s63, s2, 7
    s_mul_i32 s47, s60, 61440
    s_mul_i32 s48, s63, 160
    s_add_u32 s47, s47, s48
    s_lshl_b32 s48, s44, 10
    s_add_u32 m0, s48, 113152
    v_lshrrev_b32 v3, 5, v0
    v_lshlrev_b32 v3, 4, v3
    s_lshl_b32 s49, s60, 5
    s_waitcnt lgkmcnt(0)
    s_mov_b32 s36, s16
    s_and_b32 s37, s17, 0xffff
    s_mov_b32 s38, 2457600
    s_mov_b32 s39, 0x00020000
    s_mov_b32 s32, s20
    s_and_b32 s33, s21, 0xffff
    s_mov_b32 s34, 1280
    s_mov_b32 s35, 0x00020000
    s_mov_b32 s28, s6
    s_and_b32 s29, s7, 0xffff
    s_mov_b32 s30, 819200
    s_mov_b32 s31, 0x00020000
    s_lshl_b32 s50, s44, 5
    s_add_u32 s50, s50, s60
    s_mul_i32 s50, s50, 3840
    s_and_b32 s51, s2, 1
    s_mul_i32 s51, s51, 640
    s_add_u32 s50, s50, s51
    v_mul_u32_u24 v1, 52, v0
    v_lshrrev_b32 v1, 8, v1
    v_mul_u32_u24 v1, 640, v1
    v_lshl_add_u32 v1, v0, 7, v1
    s_mov_b32 exec_lo, 0x7fff
    s_mov_b32 exec_hi, 0x0
    buffer_load_dword v36, v1, s[28:31], s50 offen
    s_mov_b64 exec, -1
    s_barrier
    buffer_load_dwordx4 v4, s[36:39], s47 offen lds
    buffer_load_dwordx4 v[124:127], v3, s[32:35], s49 offen
    s_cmp_ge_u32 s2, 64
    s_cbranch_scc1 F_RL1
    s_add_u32 m0, s48, 121344
    s_add_u32 s47, s47, 1966080
    buffer_load_dwordx4 v4, s[36:39], s47 offen lds
    buffer_load_dwordx4 v[128:131], v3, s[32:35], s49 offen offset:1024
F_RL1:
    s_lshr_b32 s53, s44, 1
    s_and_b32 s54, s44, 1
    v_mov_b32 v1, 0
    v_lshlrev_b32 v2, 2, v0
    ds_write_b32 v2, v1
    s_mov_b32 s40, s26
    s_and_b32 s41, s27, 0xffff
    s_mov_b32 s42, 11534336
    s_mov_b32 s43, 0x00020000
    s_lshl_b32 s47, s54, 12
    s_add_u32 s47, s47, 512
    v_and_b32 v1, 31, v0
    v_lshrrev_b32 v2, 5, v0
    v_bfe_u32 v3, v0, 1, 3
    v_xor_b32 v2, v2, v3
    v_lshlrev_b32 v1, 7, v1
    v_lshl_add_u32 v1, v2, 4, v1
    v_xor_b32 v100, 0, v1
    v_add_u32 v100, s47, v100
    v_xor_b32 v101, 32, v1
    v_add_u32 v101, s47, v101
    v_xor_b32 v102, 64, v1
    v_add_u32 v102, s47, v102
    v_xor_b32 v103, 96, v1
    v_add_u32 v103, s47, v103
    s_mul_i32 s48, s53, 40
    s_add_u32 s49, s48, 113152
    s_add_u32 s48, s48, 82432
    v_lshrrev_b32 v1, 5, v0
    v_bfe_u32 v2, v0, 2, 2
    v_lshl_add_u32 v1, v1, 3, v2
    v_bfe_u32 v2, v0, 4, 1
    v_and_b32 v3, 3, v0
    v_lshl_add_u32 v2, v2, 2, v3
    v_min_u32 v2, 4, v2
    v_mul_u32_u24 v4, 160, v1
    v_lshl_add_u32 v4, v2, 3, v4
    v_add_u32 v104, s48, v4
    v_mov_b32 v106, 1
    v_mov_b32 v105, v104
    v_mul_u32_u24 v1, 480, v1
    v_add_u32 v1, s49, v1
    v_lshl_add_u32 v3, v3, 3, v1
    s_cmp_lg_u32 s54, 0
    s_cbranch_scc1 F_RL2
    v_add_u32 v132, 160, v3
    s_mov_b32 exec_lo, 0xffff0000
    s_mov_b32 exec_hi, 0xffff0000
    v_mov_b32 v132, v3
    s_branch F_RL3
F_RL2:
    v_add_u32 v132, 320, v3
    s_mov_b32 exec_lo, 0xffff0000
    s_mov_b32 exec_hi, 0xffff0000
    v_add_u32 v132, 32, v1
    s_mov_b32 exec_lo, 0x11110000
    s_mov_b32 exec_hi, 0x11110000
    v_add_u32 v132, 192, v1
    s_mov_b32 exec_lo, 0x22220000
    s_mov_b32 exec_hi, 0x22220000
    v_add_u32 v132, 352, v1
F_RL3:
    s_mov_b64 exec, -1
    v_mov_b32 v84, 0
    v_mov_b32 v85, 0
    v_mov_b32 v86, 0
    v_mov_b32 v87, 0
    v_mov_b32 v88, 0
    v_mov_b32 v89, 0
    v_mov_b32 v90, 0
    v_mov_b32 v91, 0
    v_mov_b32 v92, 0
    v_mov_b32 v93, 0
    v_mov_b32 v94, 0
    v_mov_b32 v95, 0
    v_mov_b32 v96, 0
    v_mov_b32 v97, 0
    v_mov_b32 v98, 0
    v_mov_b32 v99, 0
    v_mov_b32 v148, 0
    v_mov_b32 v149, 0
    v_mov_b32 v150, 0
    v_mov_b32 v151, 0
    v_mov_b32 v152, 0
    v_mov_b32 v153, 0
    v_mov_b32 v154, 0
    v_mov_b32 v155, 0
    v_mov_b32 v156, 0
    v_mov_b32 v157, 0
    v_mov_b32 v158, 0
    v_mov_b32 v159, 0
    v_mov_b32 v160, 0
    v_mov_b32 v161, 0
    v_mov_b32 v162, 0
    v_mov_b32 v163, 0
    v_mov_b32 v164, 0
    v_mov_b32 v165, 0
    v_mov_b32 v166, 0
    v_mov_b32 v167, 0
    v_mov_b32 v72, 0
    v_mov_b32 v73, 0
    v_mov_b32 v74, 0
    v_mov_b32 v75, 0
    v_lshlrev_b32 v5, 4, v0
    v_and_b32 v1, 31, v0
    v_lshlrev_b32 v6, 3, v1
    v_lshrrev_b32 v2, 5, v0
    v_mul_u32_u24 v2, 21, v2
    v_add_u32 v2, v2, v1
    v_lshlrev_b32 v7, 4, v2
    s_mov_b32 exec_lo, 0x0
    s_mov_b32 exec_hi, 0xffffffff
    v_mov_b32 v6, 1073741824
    s_mov_b32 exec_lo, 0xffe00000
    s_mov_b32 exec_hi, 0xffe00000
    v_mov_b32 v7, 1073741824
    s_mov_b64 exec, -1
    s_mul_i32 s59, s53, 49152
    s_addk_i32 s59, -3072
    s_mov_b32 s61, 1073741824
    s_mov_b32 s58, 0
    s_mov_b32 s57, 0
    s_mov_b32 s62, 0
    s_lshl_b32 s47, s54, 2
    v_lshlrev_b32 v3, 3, v0
    s_add_u32 s64, s53, 1
    s_and_b32 s64, s64, 3
    s_add_u32 s48, s47, s64
    s_mulk_i32 s48, 1536
    s_add_u32 s48, s48, 113152
    v_add_u32 v108, s48, v5
    v_add_u32 v112, s48, v3
    s_add_u32 s65, s53, 2
    s_and_b32 s65, s65, 3
    s_add_u32 s48, s47, s65
    s_mulk_i32 s48, 1536
    s_add_u32 s48, s48, 113152
    v_add_u32 v109, s48, v5
    v_add_u32 v113, s48, v3
    s_add_u32 s66, s53, 3
    s_and_b32 s66, s66, 3
    s_add_u32 s48, s47, s66
    s_mulk_i32 s48, 1536
    s_add_u32 s48, s48, 113152
    v_add_u32 v110, s48, v5
    v_add_u32 v114, s48, v3
    s_add_u32 s67, s53, 4
    s_and_b32 s67, s67, 3
    s_add_u32 s48, s47, s67
    s_mulk_i32 s48, 1536
    s_add_u32 s48, s48, 113152
    v_add_u32 v111, s48, v5
    v_add_u32 v115, s48, v3
    s_lshl_b32 s47, s44, 2
    v_mov_b32 v8, s47
    s_xor_b32 s47, s47, 16
    v_mov_b32 v9, s47
    s_lshl_b32 s49, s63, 2
    s_add_u32 s49, s49, s53
    s_mul_i32 s49, s49, 81920
    s_lshl_b32 s47, s60, 1
    s_add_u32 s47, s47, s54
    s_lshl_b32 s47, s47, 10
    s_add_u32 s49, s49, s47
    s_add_u32 s49, s49, 3145728
    s_add_u32 s50, s49, 65536
    s_cmp_ge_u32 s2, 64
    s_cselect_b32 s50, 1073741824, s50
    s_cmp_lg_u32 s54, 0
    s_cselect_b32 s51, 0x10000000, 0
    s_waitcnt vmcnt(0) lgkmcnt(0)
    s_barrier
    ds_read_b64_tr_b16 v[116:117], v132 offset:0
    ds_read_b64_tr_b16 v[118:119], v132 offset:1920
    ds_read_b64_tr_b16 v[120:121], v132 offset:8192
    ds_read_b64_tr_b16 v[122:123], v132 offset:10112
    s_waitcnt lgkmcnt(0)
    s_mov_b32 exec_lo, s51
    s_mov_b32 exec_hi, s51
    v_mov_b32 v116, v124
    v_mov_b32 v117, v125
    v_mov_b32 v118, v126
    v_mov_b32 v119, v127
    v_mov_b32 v120, v128
    v_mov_b32 v121, v129
    v_mov_b32 v122, v130
    v_mov_b32 v123, v131
    s_mov_b64 exec, -1
    buffer_store_dwordx4 v[116:119], v5, s[40:43], s49 offen sc1
    buffer_store_dwordx4 v[120:123], v5, s[40:43], s50 offen sc1
    s_barrier
    ds_read_b128 v[116:119], v100
    ds_read_b64_tr_b16 v[132:133], v105 offset:0
    ds_read_b64_tr_b16 v[134:135], v105 offset:640
    ds_read_b128 v[120:123], v101
    ds_read_b64_tr_b16 v[136:137], v105 offset:2560
    ds_read_b64_tr_b16 v[138:139], v105 offset:3200
    ds_read_b128 v[124:127], v102
    ds_read_b64_tr_b16 v[140:141], v105 offset:5120
    ds_read_b64_tr_b16 v[142:143], v105 offset:5760
    ds_read_b128 v[128:131], v103
    ds_read_b64_tr_b16 v[144:145], v105 offset:7680
    ds_read_b64_tr_b16 v[146:147], v105 offset:8320
    s_add_u32 s62, s62, 10240
    s_cmp_ge_u32 s62, 71680
    s_cselect_b32 s62, 0, s62
    v_mad_u32_u24 v105, v106, s62, v104
    s_branch F_Q0
F_QLOOP:
    s_barrier
    s_waitcnt lgkmcnt(0)
    v_mfma_f32_32x32x16_bf16 v[84:99], v[28:31], v[12:15], v[84:99]
    ds_read_b128 v[116:119], v100
    ds_read_b64_tr_b16 v[132:133], v105 offset:0
    ds_read_b64_tr_b16 v[134:135], v105 offset:640
    v_mfma_f32_32x32x16_bf16 v[84:99], v[32:35], v[16:19], v[84:99]
    ds_read_b128 v[120:123], v101
    ds_read_b64_tr_b16 v[136:137], v105 offset:2560
    ds_read_b64_tr_b16 v[138:139], v105 offset:3200
    v_mfma_f32_32x32x16_bf16 v[84:99], v[76:79], v[20:23], v[84:99]
    ds_read_b128 v[124:127], v102
    ds_read_b64_tr_b16 v[140:141], v105 offset:5120
    ds_read_b64_tr_b16 v[142:143], v105 offset:5760
    v_mfma_f32_32x32x16_bf16 v[84:99], v[80:83], v[24:27], v[84:99]
    ds_read_b128 v[128:131], v103
    ds_read_b64_tr_b16 v[144:145], v105 offset:7680
    ds_read_b64_tr_b16 v[146:147], v105 offset:8320
    s_add_u32 s62, s62, 10240
    s_cmp_ge_u32 s62, 71680
    s_cselect_b32 s62, 0, s62
    v_mad_u32_u24 v105, v106, s62, v104
    s_cmp_lg_u32 s57, 1
    s_cbranch_scc1 F_Q0
    s_waitcnt vmcnt(0)
F_Q0:
    s_barrier
    s_waitcnt lgkmcnt(0)
    v_mfma_f32_32x32x16_bf16 v[84:99], v[132:135], v[116:119], v[84:99]
    ds_read_b128 v[12:15], v100 offset:8192
    ds_read_b64_tr_b16 v[28:29], v105 offset:0
    ds_read_b64_tr_b16 v[30:31], v105 offset:640
    v_mfma_f32_32x32x16_bf16 v[84:99], v[136:139], v[120:123], v[84:99]
    ds_read_b128 v[16:19], v101 offset:8192
    ds_read_b64_tr_b16 v[32:33], v105 offset:2560
    ds_read_b64_tr_b16 v[34:35], v105 offset:3200
    v_mfma_f32_32x32x16_bf16 v[84:99], v[140:143], v[124:127], v[84:99]
    ds_read_b128 v[20:23], v102 offset:8192
    ds_read_b64_tr_b16 v[76:77], v105 offset:5120
    ds_read_b64_tr_b16 v[78:79], v105 offset:5760
    v_mfma_f32_32x32x16_bf16 v[84:99], v[144:147], v[128:131], v[84:99]
    ds_read_b128 v[24:27], v103 offset:8192
    ds_read_b64_tr_b16 v[80:81], v105 offset:7680
    ds_read_b64_tr_b16 v[82:83], v105 offset:8320
    s_add_u32 s62, s62, 10240
    s_cmp_ge_u32 s62, 71680
    s_cselect_b32 s62, 0, s62
    v_mad_u32_u24 v105, v106, s62, v104
    v_add_u32 v100, 16384, v100
    v_add_u32 v101, 16384, v101
    v_add_u32 v102, 16384, v102
    v_add_u32 v103, 16384, v103
    s_add_u32 s57, s57, 1
    s_cmp_lg_u32 s57, 5
    s_cbranch_scc1 F_QLOOP
    s_mov_b32 s55, s59
    s_mov_b32 s56, s59
    s_addk_i32 s55, 3072
    buffer_load_dwordx4 v[36:39], v5, s[40:43], s55 offen sc1
    buffer_load_dwordx2 v[10:11], v6, s[40:43], s55 offen offset:2560 sc1
    v_mov_b32 v116, 0
    v_mov_b32 v117, 0
    v_mov_b32 v118, 0
    v_mov_b32 v119, 0
    v_mov_b32 v120, 0
    v_mov_b32 v121, 0
    v_mov_b32 v122, 0
    v_mov_b32 v123, 0
    v_mov_b32 v124, 0
    v_mov_b32 v125, 0
    v_mov_b32 v126, 0
    v_mov_b32 v127, 0
    v_mov_b32 v128, 0
    v_mov_b32 v129, 0
    v_mov_b32 v130, 0
    v_mov_b32 v131, 0
    v_mov_b32 v132, 0
    v_mov_b32 v133, 0
    v_mov_b32 v134, 0
    v_mov_b32 v135, 0
    v_mov_b32 v136, 0
    v_mov_b32 v137, 0
    v_mov_b32 v138, 0
    v_mov_b32 v139, 0
    v_mov_b32 v140, 0
    v_mov_b32 v141, 0
    v_mov_b32 v142, 0
    v_mov_b32 v143, 0
    v_mov_b32 v144, 0
    v_mov_b32 v145, 0
    v_mov_b32 v146, 0
    v_mov_b32 v147, 0
    s_waitcnt lgkmcnt(0)
    v_mfma_f32_32x32x16_bf16 v[84:99], v[28:31], v[12:15], v[84:99]
    v_mfma_f32_32x32x16_bf16 v[84:99], v[32:35], v[16:19], v[84:99]
    v_mfma_f32_32x32x16_bf16 v[84:99], v[76:79], v[20:23], v[84:99]
    v_mfma_f32_32x32x16_bf16 v[84:99], v[80:83], v[24:27], v[84:99]
    s_addk_i32 s56, 3072
    buffer_load_dwordx4 v[52:55], v7, s[40:43], s56 offen offset:1024 sc1
    buffer_load_dwordx4 v[64:67], v7, s[40:43], s56 offen offset:1792 sc1
    s_addk_i32 s55, 3072
    buffer_load_dwordx4 v[40:43], v5, s[40:43], s55 offen sc1
    buffer_load_dwordx2 v[48:49], v6, s[40:43], s55 offen offset:2560 sc1
    s_lshl_b32 s47, s45, 1
    s_add_u32 s47, s47, s54
    s_lshl_b32 s47, s47, 5
    s_lshl_b32 s48, s46, 2
    s_add_u32 s48, s48, s53
    s_add_u32 s48, s48, s47
    s_mul_i32 s48, s48, 1280
    s_add_u32 s60, s48, 6291456
    s_nop 2
    s_mov_b32 s57, 0
    v_cvt_pk_bf16_f32 v76, v84, v85
    v_cvt_pk_bf16_f32 v77, v86, v87
    v_cvt_pk_bf16_f32 v78, v88, v89
    v_cvt_pk_bf16_f32 v79, v90, v91
    v_cvt_pk_bf16_f32 v80, v92, v93
    v_cvt_pk_bf16_f32 v81, v94, v95
    s_mov_b32 exec_lo, 0
    v_mov_b32 v80, 0
    v_mov_b32 v81, 0
    s_mov_b64 exec, -1
    ds_write_b128 v111, v[76:79]
    ds_write_b64 v115, v[80:81] offset:1024
    s_waitcnt lgkmcnt(0)
    s_barrier
    ds_read_b128 v[12:15], v108
    ds_read_b64 v[28:29], v112 offset:1024
    ds_read_b128 v[16:19], v109
    ds_read_b64 v[30:31], v113 offset:1024
    ds_read_b128 v[20:23], v110
    ds_read_b64 v[32:33], v114 offset:1024
    ds_read_b128 v[24:27], v111
    ds_read_b64 v[34:35], v115 offset:1024
    s_addk_i32 s56, 3072
    buffer_load_dwordx4 v[56:59], v7, s[40:43], s56 offen offset:1024 sc1
    buffer_load_dwordx4 v[68:71], v7, s[40:43], s56 offen offset:1792 sc1
    s_addk_i32 s55, 3072
    buffer_load_dwordx4 v[44:47], v5, s[40:43], s55 offen sc1
    buffer_load_dwordx2 v[50:51], v6, s[40:43], s55 offen offset:2560 sc1
    v_mov_b32 v80, 0
    v_mov_b32 v81, 0
    v_mov_b32 v82, 0
    v_mov_b32 v83, 0
    s_waitcnt vmcnt(8) lgkmcnt(6)
    v_mfma_f32_32x32x16_bf16 v[84:99], v[36:39], v[12:15], 0
    v_mfma_f32_32x32x8_bf16 v[84:99], v[10:11], v[28:29], v[84:99]
    s_waitcnt lgkmcnt(0)
    s_barrier
    s_setprio 1
    s_nop 7
    s_mov_b32 s62, 0
    s_lshl_b32 s52, s44, 8
    s_and_b32 s52, s52, 0x400
.p2align 6
F_LOOP:
    s_add_u32 s62, s62, 1
    v_mov_b32 v1, s62
    ds_read_b32 v2, v9 offset:64
    ds_write_b32 v8, v1 offset:64
    v_mfma_f32_32x32x16_bf16 v[100:115], v[36:39], v[16:19], 0
    v_exp_f32 v84, v84
    v_exp_f32 v85, v85
    v_exp_f32 v86, v86
    v_exp_f32 v87, v87
    v_cvt_pk_bf16_f32 v76, v84, v85
    v_cvt_pk_bf16_f32 v77, v86, v87
    v_mfma_f32_32x32x16_bf16 v[152:167], v[72:75], v[80:83], v[152:167]
    s_waitcnt vmcnt(6)
    s_addk_i32 s56, 3072
    buffer_load_dwordx4 v[60:63], v7, s[40:43], s56 offen offset:1024 sc1
    buffer_load_dwordx4 v[72:75], v7, s[40:43], s56 offen offset:1792 sc1
    v_exp_f32 v88, v88
    v_exp_f32 v89, v89
    v_exp_f32 v90, v90
    v_exp_f32 v91, v91
    v_cvt_pk_bf16_f32 v78, v88, v89
    v_cvt_pk_bf16_f32 v79, v90, v91
    v_mfma_f32_32x32x8_bf16 v[100:115], v[10:11], v[30:31], v[100:115]
    v_exp_f32 v92, v92
    v_exp_f32 v93, v93
    v_exp_f32 v94, v94
    v_exp_f32 v95, v95
    v_cvt_pk_bf16_f32 v80, v92, v93
    v_cvt_pk_bf16_f32 v81, v94, v95
    v_mfma_f32_32x32x16_bf16 v[116:131], v[52:55], v[76:79], v[116:131]
    v_exp_f32 v96, v96
    v_exp_f32 v97, v97
    v_exp_f32 v98, v98
    v_exp_f32 v99, v99
    v_cvt_pk_bf16_f32 v82, v96, v97
    v_cvt_pk_bf16_f32 v83, v98, v99
    s_waitcnt lgkmcnt(0)
    v_readfirstlane_b32 s47, v2
    v_mfma_f32_32x32x16_bf16 v[84:99], v[36:39], v[20:23], 0
    v_exp_f32 v100, v100
    v_exp_f32 v101, v101
    v_exp_f32 v102, v102
    v_exp_f32 v103, v103
    v_cvt_pk_bf16_f32 v76, v100, v101
    v_cvt_pk_bf16_f32 v77, v102, v103
    v_mfma_f32_32x32x16_bf16 v[116:131], v[64:67], v[80:83], v[116:131]
    v_exp_f32 v104, v104
    v_exp_f32 v105, v105
    v_exp_f32 v106, v106
    v_exp_f32 v107, v107
    v_cvt_pk_bf16_f32 v78, v104, v105
    v_cvt_pk_bf16_f32 v79, v106, v107
    v_mfma_f32_32x32x8_bf16 v[84:99], v[10:11], v[32:33], v[84:99]
    v_exp_f32 v108, v108
    v_exp_f32 v109, v109
    v_exp_f32 v110, v110
    v_exp_f32 v111, v111
    v_cvt_pk_bf16_f32 v80, v108, v109
    v_cvt_pk_bf16_f32 v81, v110, v111
    v_mfma_f32_32x32x16_bf16 v[128:143], v[52:55], v[76:79], v[128:143]
    v_exp_f32 v112, v112
    v_exp_f32 v113, v113
    v_exp_f32 v114, v114
    v_exp_f32 v115, v115
    v_cvt_pk_bf16_f32 v82, v112, v113
    v_cvt_pk_bf16_f32 v83, v114, v115
    s_or_b32 s47, s47, s52
    s_cmp_gt_u32 s62, s47
    s_setprio 2
    s_cbranch_scc0 F_FAIR2
    s_setprio 1
F_FAIR2:
    v_mfma_f32_32x32x16_bf16 v[100:115], v[36:39], v[24:27], 0
    v_exp_f32 v84, v84
    v_exp_f32 v85, v85
    v_exp_f32 v86, v86
    v_exp_f32 v87, v87
    v_cvt_pk_bf16_f32 v76, v84, v85
    v_cvt_pk_bf16_f32 v77, v86, v87
    v_mfma_f32_32x32x16_bf16 v[128:143], v[64:67], v[80:83], v[128:143]
    v_exp_f32 v88, v88
    v_exp_f32 v89, v89
    v_exp_f32 v90, v90
    v_exp_f32 v91, v91
    v_cvt_pk_bf16_f32 v78, v88, v89
    v_cvt_pk_bf16_f32 v79, v90, v91
    v_mfma_f32_32x32x8_bf16 v[100:115], v[10:11], v[34:35], v[100:115]
    v_exp_f32 v92, v92
    v_exp_f32 v93, v93
    v_exp_f32 v94, v94
    v_exp_f32 v95, v95
    v_cvt_pk_bf16_f32 v80, v92, v93
    v_cvt_pk_bf16_f32 v81, v94, v95
    v_mfma_f32_32x32x16_bf16 v[140:155], v[52:55], v[76:79], v[140:155]
    v_exp_f32 v96, v96
    v_exp_f32 v97, v97
    v_exp_f32 v98, v98
    v_exp_f32 v99, v99
    v_cvt_pk_bf16_f32 v82, v96, v97
    v_cvt_pk_bf16_f32 v83, v98, v99
    s_waitcnt vmcnt(6)
    s_addk_i32 s55, 3072
    buffer_load_dwordx4 v[36:39], v5, s[40:43], s55 offen sc1
    buffer_load_dwordx2 v[10:11], v6, s[40:43], s55 offen offset:2560 sc1
    v_mfma_f32_32x32x16_bf16 v[84:99], v[40:43], v[12:15], 0
    v_exp_f32 v100, v100
    v_exp_f32 v101, v101
    v_exp_f32 v102, v102
    v_exp_f32 v103, v103
    v_cvt_pk_bf16_f32 v76, v100, v101
    v_cvt_pk_bf16_f32 v77, v102, v103
    v_mfma_f32_32x32x16_bf16 v[140:155], v[64:67], v[80:83], v[140:155]
    v_exp_f32 v104, v104
    v_exp_f32 v105, v105
    v_exp_f32 v106, v106
    v_exp_f32 v107, v107
    v_cvt_pk_bf16_f32 v78, v104, v105
    v_cvt_pk_bf16_f32 v79, v106, v107
    v_mfma_f32_32x32x8_bf16 v[84:99], v[48:49], v[28:29], v[84:99]
    v_exp_f32 v108, v108
    v_exp_f32 v109, v109
    v_exp_f32 v110, v110
    v_exp_f32 v111, v111
    v_cvt_pk_bf16_f32 v80, v108, v109
    v_cvt_pk_bf16_f32 v81, v110, v111
    v_mfma_f32_32x32x16_bf16 v[152:167], v[52:55], v[76:79], v[152:167]
    v_exp_f32 v112, v112
    v_exp_f32 v113, v113
    v_exp_f32 v114, v114
    v_exp_f32 v115, v115
    v_cvt_pk_bf16_f32 v82, v112, v113
    v_cvt_pk_bf16_f32 v83, v114, v115
    v_mfma_f32_32x32x16_bf16 v[100:115], v[40:43], v[16:19], 0
    v_exp_f32 v84, v84
    v_exp_f32 v85, v85
    v_exp_f32 v86, v86
    v_exp_f32 v87, v87
    v_cvt_pk_bf16_f32 v76, v84, v85
    v_cvt_pk_bf16_f32 v77, v86, v87
    v_mfma_f32_32x32x16_bf16 v[152:167], v[64:67], v[80:83], v[152:167]
    s_waitcnt vmcnt(6)
    s_addk_i32 s56, 3072
    buffer_load_dwordx4 v[52:55], v7, s[40:43], s56 offen offset:1024 sc1
    buffer_load_dwordx4 v[64:67], v7, s[40:43], s56 offen offset:1792 sc1
    v_exp_f32 v88, v88
    v_exp_f32 v89, v89
    v_exp_f32 v90, v90
    v_exp_f32 v91, v91
    v_cvt_pk_bf16_f32 v78, v88, v89
    v_cvt_pk_bf16_f32 v79, v90, v91
    v_mfma_f32_32x32x8_bf16 v[100:115], v[48:49], v[30:31], v[100:115]
    v_exp_f32 v92, v92
    v_exp_f32 v93, v93
    v_exp_f32 v94, v94
    v_exp_f32 v95, v95
    v_cvt_pk_bf16_f32 v80, v92, v93
    v_cvt_pk_bf16_f32 v81, v94, v95
    v_mfma_f32_32x32x16_bf16 v[116:131], v[56:59], v[76:79], v[116:131]
    v_exp_f32 v96, v96
    v_exp_f32 v97, v97
    v_exp_f32 v98, v98
    v_exp_f32 v99, v99
    v_cvt_pk_bf16_f32 v82, v96, v97
    v_cvt_pk_bf16_f32 v83, v98, v99
    v_mfma_f32_32x32x16_bf16 v[84:99], v[40:43], v[20:23], 0
    v_exp_f32 v100, v100
    v_exp_f32 v101, v101
    v_exp_f32 v102, v102
    v_exp_f32 v103, v103
    v_cvt_pk_bf16_f32 v76, v100, v101
    v_cvt_pk_bf16_f32 v77, v102, v103
    v_mfma_f32_32x32x16_bf16 v[116:131], v[68:71], v[80:83], v[116:131]
    v_exp_f32 v104, v104
    v_exp_f32 v105, v105
    v_exp_f32 v106, v106
    v_exp_f32 v107, v107
    v_cvt_pk_bf16_f32 v78, v104, v105
    v_cvt_pk_bf16_f32 v79, v106, v107
    v_mfma_f32_32x32x8_bf16 v[84:99], v[48:49], v[32:33], v[84:99]
    v_exp_f32 v108, v108
    v_exp_f32 v109, v109
    v_exp_f32 v110, v110
    v_exp_f32 v111, v111
    v_cvt_pk_bf16_f32 v80, v108, v109
    v_cvt_pk_bf16_f32 v81, v110, v111
    v_mfma_f32_32x32x16_bf16 v[128:143], v[56:59], v[76:79], v[128:143]
    v_exp_f32 v112, v112
    v_exp_f32 v113, v113
    v_exp_f32 v114, v114
    v_exp_f32 v115, v115
    v_cvt_pk_bf16_f32 v82, v112, v113
    v_cvt_pk_bf16_f32 v83, v114, v115
    s_add_u32 s62, s62, 1
    v_mov_b32 v1, s62
    ds_read_b32 v2, v9 offset:64
    ds_write_b32 v8, v1 offset:64
    v_mfma_f32_32x32x16_bf16 v[100:115], v[40:43], v[24:27], 0
    v_exp_f32 v84, v84
    v_exp_f32 v85, v85
    v_exp_f32 v86, v86
    v_exp_f32 v87, v87
    v_cvt_pk_bf16_f32 v76, v84, v85
    v_cvt_pk_bf16_f32 v77, v86, v87
    v_mfma_f32_32x32x16_bf16 v[128:143], v[68:71], v[80:83], v[128:143]
    v_exp_f32 v88, v88
    v_exp_f32 v89, v89
    v_exp_f32 v90, v90
    v_exp_f32 v91, v91
    v_cvt_pk_bf16_f32 v78, v88, v89
    v_cvt_pk_bf16_f32 v79, v90, v91
    v_mfma_f32_32x32x8_bf16 v[100:115], v[48:49], v[34:35], v[100:115]
    v_exp_f32 v92, v92
    v_exp_f32 v93, v93
    v_exp_f32 v94, v94
    v_exp_f32 v95, v95
    v_cvt_pk_bf16_f32 v80, v92, v93
    v_cvt_pk_bf16_f32 v81, v94, v95
    v_mfma_f32_32x32x16_bf16 v[140:155], v[56:59], v[76:79], v[140:155]
    v_exp_f32 v96, v96
    v_exp_f32 v97, v97
    v_exp_f32 v98, v98
    v_exp_f32 v99, v99
    v_cvt_pk_bf16_f32 v82, v96, v97
    v_cvt_pk_bf16_f32 v83, v98, v99
    s_add_u32 s57, s57, 1
    s_cmp_eq_u32 s57, 5
    s_cselect_b32 s55, s61, s55
    s_cselect_b32 s56, s61, s56
    s_waitcnt vmcnt(6)
    s_addk_i32 s55, 3072
    buffer_load_dwordx4 v[40:43], v5, s[40:43], s55 offen sc1
    buffer_load_dwordx2 v[48:49], v6, s[40:43], s55 offen offset:2560 sc1
    s_waitcnt lgkmcnt(0)
    v_readfirstlane_b32 s47, v2
    v_mfma_f32_32x32x16_bf16 v[84:99], v[44:47], v[12:15], 0
    v_exp_f32 v100, v100
    v_exp_f32 v101, v101
    v_exp_f32 v102, v102
    v_exp_f32 v103, v103
    v_cvt_pk_bf16_f32 v76, v100, v101
    v_cvt_pk_bf16_f32 v77, v102, v103
    v_mfma_f32_32x32x16_bf16 v[140:155], v[68:71], v[80:83], v[140:155]
    v_exp_f32 v104, v104
    v_exp_f32 v105, v105
    v_exp_f32 v106, v106
    v_exp_f32 v107, v107
    v_cvt_pk_bf16_f32 v78, v104, v105
    v_cvt_pk_bf16_f32 v79, v106, v107
    v_mfma_f32_32x32x8_bf16 v[84:99], v[50:51], v[28:29], v[84:99]
    v_exp_f32 v108, v108
    v_exp_f32 v109, v109
    v_exp_f32 v110, v110
    v_exp_f32 v111, v111
    v_cvt_pk_bf16_f32 v80, v108, v109
    v_cvt_pk_bf16_f32 v81, v110, v111
    v_mfma_f32_32x32x16_bf16 v[152:167], v[56:59], v[76:79], v[152:167]
    v_exp_f32 v112, v112
    v_exp_f32 v113, v113
    v_exp_f32 v114, v114
    v_exp_f32 v115, v115
    v_cvt_pk_bf16_f32 v82, v112, v113
    v_cvt_pk_bf16_f32 v83, v114, v115
    s_or_b32 s47, s47, s52
    s_cmp_gt_u32 s62, s47
    s_setprio 2
    s_cbranch_scc0 F_FAIR3
    s_setprio 1
F_FAIR3:
    v_mfma_f32_32x32x16_bf16 v[100:115], v[44:47], v[16:19], 0
    v_exp_f32 v84, v84
    v_exp_f32 v85, v85
    v_exp_f32 v86, v86
    v_exp_f32 v87, v87
    v_cvt_pk_bf16_f32 v76, v84, v85
    v_cvt_pk_bf16_f32 v77, v86, v87
    v_mfma_f32_32x32x16_bf16 v[152:167], v[68:71], v[80:83], v[152:167]
    s_waitcnt vmcnt(6)
    s_addk_i32 s56, 3072
    buffer_load_dwordx4 v[56:59], v7, s[40:43], s56 offen offset:1024 sc1
    buffer_load_dwordx4 v[68:71], v7, s[40:43], s56 offen offset:1792 sc1
    v_exp_f32 v88, v88
    v_exp_f32 v89, v89
    v_exp_f32 v90, v90
    v_exp_f32 v91, v91
    v_cvt_pk_bf16_f32 v78, v88, v89
    v_cvt_pk_bf16_f32 v79, v90, v91
    v_mfma_f32_32x32x8_bf16 v[100:115], v[50:51], v[30:31], v[100:115]
    v_exp_f32 v92, v92
    v_exp_f32 v93, v93
    v_exp_f32 v94, v94
    v_exp_f32 v95, v95
    v_cvt_pk_bf16_f32 v80, v92, v93
    v_cvt_pk_bf16_f32 v81, v94, v95
    v_mfma_f32_32x32x16_bf16 v[116:131], v[60:63], v[76:79], v[116:131]
    v_exp_f32 v96, v96
    v_exp_f32 v97, v97
    v_exp_f32 v98, v98
    v_exp_f32 v99, v99
    v_cvt_pk_bf16_f32 v82, v96, v97
    v_cvt_pk_bf16_f32 v83, v98, v99
    v_mfma_f32_32x32x16_bf16 v[84:99], v[44:47], v[20:23], 0
    v_exp_f32 v100, v100
    v_exp_f32 v101, v101
    v_exp_f32 v102, v102
    v_exp_f32 v103, v103
    v_cvt_pk_bf16_f32 v76, v100, v101
    v_cvt_pk_bf16_f32 v77, v102, v103
    v_mfma_f32_32x32x16_bf16 v[116:131], v[72:75], v[80:83], v[116:131]
    v_exp_f32 v104, v104
    v_exp_f32 v105, v105
    v_exp_f32 v106, v106
    v_exp_f32 v107, v107
    v_cvt_pk_bf16_f32 v78, v104, v105
    v_cvt_pk_bf16_f32 v79, v106, v107
    v_mfma_f32_32x32x8_bf16 v[84:99], v[50:51], v[32:33], v[84:99]
    v_exp_f32 v108, v108
    v_exp_f32 v109, v109
    v_exp_f32 v110, v110
    v_exp_f32 v111, v111
    v_cvt_pk_bf16_f32 v80, v108, v109
    v_cvt_pk_bf16_f32 v81, v110, v111
    v_mfma_f32_32x32x16_bf16 v[128:143], v[60:63], v[76:79], v[128:143]
    v_exp_f32 v112, v112
    v_exp_f32 v113, v113
    v_exp_f32 v114, v114
    v_exp_f32 v115, v115
    v_cvt_pk_bf16_f32 v82, v112, v113
    v_cvt_pk_bf16_f32 v83, v114, v115
    v_mfma_f32_32x32x16_bf16 v[100:115], v[44:47], v[24:27], 0
    v_exp_f32 v84, v84
    v_exp_f32 v85, v85
    v_exp_f32 v86, v86
    v_exp_f32 v87, v87
    v_cvt_pk_bf16_f32 v76, v84, v85
    v_cvt_pk_bf16_f32 v77, v86, v87
    v_mfma_f32_32x32x16_bf16 v[128:143], v[72:75], v[80:83], v[128:143]
    v_exp_f32 v88, v88
    v_exp_f32 v89, v89
    v_exp_f32 v90, v90
    v_exp_f32 v91, v91
    v_cvt_pk_bf16_f32 v78, v88, v89
    v_cvt_pk_bf16_f32 v79, v90, v91
    v_mfma_f32_32x32x8_bf16 v[100:115], v[50:51], v[34:35], v[100:115]
    v_exp_f32 v92, v92
    v_exp_f32 v93, v93
    v_exp_f32 v94, v94
    v_exp_f32 v95, v95
    v_cvt_pk_bf16_f32 v80, v92, v93
    v_cvt_pk_bf16_f32 v81, v94, v95
    v_mfma_f32_32x32x16_bf16 v[140:155], v[60:63], v[76:79], v[140:155]
    v_exp_f32 v96, v96
    v_exp_f32 v97, v97
    v_exp_f32 v98, v98
    v_exp_f32 v99, v99
    v_cvt_pk_bf16_f32 v82, v96, v97
    v_cvt_pk_bf16_f32 v83, v98, v99
    s_waitcnt vmcnt(6)
    s_addk_i32 s55, 3072
    buffer_load_dwordx4 v[44:47], v5, s[40:43], s55 offen sc1
    buffer_load_dwordx2 v[50:51], v6, s[40:43], s55 offen offset:2560 sc1
    v_mfma_f32_32x32x16_bf16 v[84:99], v[36:39], v[12:15], 0
    v_exp_f32 v100, v100
    v_exp_f32 v101, v101
    v_exp_f32 v102, v102
    v_exp_f32 v103, v103
    v_cvt_pk_bf16_f32 v76, v100, v101
    v_cvt_pk_bf16_f32 v77, v102, v103
    v_mfma_f32_32x32x16_bf16 v[140:155], v[72:75], v[80:83], v[140:155]
    v_exp_f32 v104, v104
    v_exp_f32 v105, v105
    v_exp_f32 v106, v106
    v_exp_f32 v107, v107
    v_cvt_pk_bf16_f32 v78, v104, v105
    v_cvt_pk_bf16_f32 v79, v106, v107
    v_mfma_f32_32x32x8_bf16 v[84:99], v[10:11], v[28:29], v[84:99]
    v_exp_f32 v108, v108
    v_exp_f32 v109, v109
    v_exp_f32 v110, v110
    v_exp_f32 v111, v111
    v_cvt_pk_bf16_f32 v80, v108, v109
    v_cvt_pk_bf16_f32 v81, v110, v111
    v_mfma_f32_32x32x16_bf16 v[152:167], v[60:63], v[76:79], v[152:167]
    v_exp_f32 v112, v112
    v_exp_f32 v113, v113
    v_exp_f32 v114, v114
    v_exp_f32 v115, v115
    v_cvt_pk_bf16_f32 v82, v112, v113
    v_cvt_pk_bf16_f32 v83, v114, v115
    s_cmp_lt_u32 s57, 5
    s_cbranch_scc1 F_LOOP
    v_mov_b32_e64 v1, 0
    ds_read_b32 v2, v1 offset:16
    v_mfma_f32_32x32x16_bf16 v[100:115], v[36:39], v[16:19], 0
    v_exp_f32 v84, v84
    v_exp_f32 v85, v85
    v_exp_f32 v86, v86
    v_exp_f32 v87, v87
    v_cvt_pk_bf16_f32 v76, v84, v85
    v_cvt_pk_bf16_f32 v77, v86, v87
    v_mfma_f32_32x32x16_bf16 v[152:167], v[72:75], v[80:83], v[152:167]
    s_waitcnt vmcnt(6)
    s_mov_b32 s48, 0
    v_exp_f32 v88, v88
    v_exp_f32 v89, v89
    v_exp_f32 v90, v90
    v_exp_f32 v91, v91
    v_cvt_pk_bf16_f32 v78, v88, v89
    v_cvt_pk_bf16_f32 v79, v90, v91
    v_mfma_f32_32x32x8_bf16 v[100:115], v[10:11], v[30:31], v[100:115]
    v_exp_f32 v92, v92
    v_exp_f32 v93, v93
    v_exp_f32 v94, v94
    v_exp_f32 v95, v95
    v_cvt_pk_bf16_f32 v80, v92, v93
    v_cvt_pk_bf16_f32 v81, v94, v95
    v_mfma_f32_32x32x16_bf16 v[116:131], v[52:55], v[76:79], v[116:131]
    v_exp_f32 v96, v96
    v_exp_f32 v97, v97
    v_exp_f32 v98, v98
    v_exp_f32 v99, v99
    v_cvt_pk_bf16_f32 v82, v96, v97
    v_cvt_pk_bf16_f32 v83, v98, v99
    v_mfma_f32_32x32x16_bf16 v[84:99], v[36:39], v[20:23], 0
    v_exp_f32 v100, v100
    v_exp_f32 v101, v101
    v_exp_f32 v102, v102
    v_exp_f32 v103, v103
    v_cvt_pk_bf16_f32 v76, v100, v101
    v_cvt_pk_bf16_f32 v77, v102, v103
    v_mfma_f32_32x32x16_bf16 v[116:131], v[64:67], v[80:83], v[116:131]
    s_waitcnt lgkmcnt(0)
    v_readfirstlane_b32 s51, v2
    s_lshl_b32 s47, s64, 1
    s_add_u32 s47, s47, s54
    s_mul_i32 s47, s47, 9216
    s_add_u32 s47, s47, 8192
    v_add_u32 v8, s47, v5
    s_lshl_b32 s47, s65, 1
    s_add_u32 s47, s47, s54
    s_mul_i32 s47, s47, 9216
    s_add_u32 s47, s47, 11264
    v_add_u32 v9, s47, v5
    v_exp_f32 v104, v104
    v_exp_f32 v105, v105
    v_exp_f32 v106, v106
    v_exp_f32 v107, v107
    v_cvt_pk_bf16_f32 v78, v104, v105
    v_cvt_pk_bf16_f32 v79, v106, v107
    v_mfma_f32_32x32x8_bf16 v[84:99], v[10:11], v[32:33], v[84:99]
    v_exp_f32 v108, v108
    v_exp_f32 v109, v109
    v_exp_f32 v110, v110
    v_exp_f32 v111, v111
    v_cvt_pk_bf16_f32 v80, v108, v109
    v_cvt_pk_bf16_f32 v81, v110, v111
    v_mfma_f32_32x32x16_bf16 v[128:143], v[52:55], v[76:79], v[128:143]
    v_exp_f32 v112, v112
    v_exp_f32 v113, v113
    v_exp_f32 v114, v114
    v_exp_f32 v115, v115
    v_cvt_pk_bf16_f32 v82, v112, v113
    v_cvt_pk_bf16_f32 v83, v114, v115
    v_mfma_f32_32x32x16_bf16 v[100:115], v[36:39], v[24:27], 0
    v_exp_f32 v84, v84
    v_exp_f32 v85, v85
    v_exp_f32 v86, v86
    v_exp_f32 v87, v87
    v_cvt_pk_bf16_f32 v76, v84, v85
    v_cvt_pk_bf16_f32 v77, v86, v87
    v_mfma_f32_32x32x16_bf16 v[128:143], v[64:67], v[80:83], v[128:143]
    s_cmp_lt_u32 s51, 4
    s_cbranch_scc1 F_EW4
    ds_write_b128 v8, v[116:119]
    ds_write_b128 v8, v[120:123] offset:1024
    ds_write_b128 v8, v[124:127] offset:2048
F_EW4:
    s_lshl_b32 s47, s66, 1
    s_add_u32 s47, s47, s54
    s_mul_i32 s47, s47, 9216
    s_add_u32 s47, s47, 14336
    v_add_u32 v3, s47, v5
    v_exp_f32 v88, v88
    v_exp_f32 v89, v89
    v_exp_f32 v90, v90
    v_exp_f32 v91, v91
    v_cvt_pk_bf16_f32 v78, v88, v89
    v_cvt_pk_bf16_f32 v79, v90, v91
    v_mfma_f32_32x32x8_bf16 v[100:115], v[10:11], v[34:35], v[100:115]
    v_exp_f32 v92, v92
    v_exp_f32 v93, v93
    v_exp_f32 v94, v94
    v_exp_f32 v95, v95
    v_cvt_pk_bf16_f32 v80, v92, v93
    v_cvt_pk_bf16_f32 v81, v94, v95
    v_mfma_f32_32x32x16_bf16 v[140:155], v[52:55], v[76:79], v[140:155]
    v_exp_f32 v96, v96
    v_exp_f32 v97, v97
    v_exp_f32 v98, v98
    v_exp_f32 v99, v99
    v_cvt_pk_bf16_f32 v82, v96, v97
    v_cvt_pk_bf16_f32 v83, v98, v99
    v_exp_f32 v100, v100
    v_exp_f32 v101, v101
    v_exp_f32 v102, v102
    v_exp_f32 v103, v103
    v_cvt_pk_bf16_f32 v76, v100, v101
    v_cvt_pk_bf16_f32 v77, v102, v103
    v_mfma_f32_32x32x16_bf16 v[140:155], v[64:67], v[80:83], v[140:155]
    s_cmp_lt_u32 s51, 4
    s_cbranch_scc1 F_EW5
    ds_write_b128 v9, v[128:131]
    ds_write_b128 v9, v[132:135] offset:1024
    ds_write_b128 v9, v[136:139] offset:2048
F_EW5:
    v_exp_f32 v104, v104
    v_exp_f32 v105, v105
    v_exp_f32 v106, v106
    v_exp_f32 v107, v107
    v_cvt_pk_bf16_f32 v78, v104, v105
    v_cvt_pk_bf16_f32 v79, v106, v107
    v_exp_f32 v108, v108
    v_exp_f32 v109, v109
    v_exp_f32 v110, v110
    v_exp_f32 v111, v111
    v_cvt_pk_bf16_f32 v80, v108, v109
    v_cvt_pk_bf16_f32 v81, v110, v111
    v_mfma_f32_32x32x16_bf16 v[152:167], v[52:55], v[76:79], v[152:167]
    s_cmp_lt_u32 s51, 4
    s_cbranch_scc1 F_EW6
    ds_write_b128 v3, v[140:143]
    ds_write_b128 v3, v[144:147] offset:1024
    ds_write_b128 v3, v[148:151] offset:2048
F_EW6:
    v_exp_f32 v112, v112
    v_exp_f32 v113, v113
    v_exp_f32 v114, v114
    v_exp_f32 v115, v115
    v_cvt_pk_bf16_f32 v82, v112, v113
    v_cvt_pk_bf16_f32 v83, v114, v115
    s_mul_i32 s47, s44, 9216
    s_add_u32 s47, s47, 8192
    v_mfma_f32_32x32x16_bf16 v[152:167], v[64:67], v[80:83], v[152:167]
    s_cmp_ge_u32 s51, 4
    s_cbranch_scc1 F_RED
F_HR:
    ds_read_b32 v2, v1 offset:16
    s_waitcnt lgkmcnt(0)
    v_readfirstlane_b32 s51, v2
    s_add_u32 s48, s48, 1
    s_cmp_ge_u32 s48, 1048576
    s_cbranch_scc1 F_HROK
    s_cmp_ge_u32 s51, 4
    s_cbranch_scc1 F_HROK
    s_sleep 2
    s_branch F_HR
F_HROK:
    ds_write_b128 v8, v[116:119]
    ds_write_b128 v8, v[120:123] offset:1024
    ds_write_b128 v8, v[124:127] offset:2048
    ds_write_b128 v9, v[128:131]
    ds_write_b128 v9, v[132:135] offset:1024
    ds_write_b128 v9, v[136:139] offset:2048
    ds_write_b128 v3, v[140:143]
    ds_write_b128 v3, v[144:147] offset:1024
    ds_write_b128 v3, v[148:151] offset:2048
F_RED:
    v_add_u32 v8, s47, v5
    v_and_b32 v3, 31, v0
    s_lshl_b32 s48, s54, 7
    v_lshl_add_u32 v4, v3, 2, s48
    ds_read_b32 v4, v4 offset:256
    v_mov_b32 v84, 0x2b800000
    v_mov_b32 v85, 0x5d800000
    s_waitcnt lgkmcnt(0)
    s_barrier
    ds_read_b128 v[124:127], v8 offset:2048
    ds_read_b128 v[136:139], v8 offset:5120
    ds_read_b128 v[148:151], v8 offset:8192
    ds_read_b128 v[116:119], v8 offset:0
    ds_read_b128 v[128:131], v8 offset:3072
    ds_read_b128 v[140:143], v8 offset:6144
    ds_read_b128 v[120:123], v8 offset:1024
    ds_read_b128 v[132:135], v8 offset:4096
    ds_read_b128 v[144:147], v8 offset:7168
    s_waitcnt lgkmcnt(6)
    v_pk_add_f32 v[124:125], v[124:125], v[160:161]
    v_pk_add_f32 v[136:137], v[136:137], v[148:149]
    v_pk_add_f32 v[126:127], v[126:127], v[162:163]
    v_pk_add_f32 v[138:139], v[138:139], v[150:151]
    v_pk_add_f32 v[124:125], v[124:125], v[136:137]
    v_pk_add_f32 v[126:127], v[126:127], v[138:139]
    v_mov_b32 v1, v124
    v_mov_b32 v2, v124
    s_nop 1
    v_permlane32_swap_b32 v1, v2
    s_waitcnt lgkmcnt(3)
    v_pk_add_f32 v[116:117], v[116:117], v[152:153]
    v_pk_add_f32 v[128:129], v[128:129], v[140:141]
    v_pk_add_f32 v[118:119], v[118:119], v[154:155]
    v_pk_add_f32 v[130:131], v[130:131], v[142:143]
    v_rcp_f32 v86, v2
    v_cmp_nge_f32 vcc, v2, v84
    v_cmp_nle_f32 s[50:51], v2, v85
    v_pk_add_f32 v[116:117], v[116:117], v[128:129]
    v_pk_add_f32 v[118:119], v[118:119], v[130:131]
    v_mul_f32 v86, v86, v4
    s_or_b64 vcc, vcc, s[50:51]
    s_waitcnt lgkmcnt(0)
    v_pk_add_f32 v[120:121], v[120:121], v[156:157]
    v_pk_add_f32 v[132:133], v[132:133], v[144:145]
    v_pk_add_f32 v[122:123], v[122:123], v[158:159]
    v_pk_add_f32 v[134:135], v[134:135], v[146:147]
    v_pk_add_f32 v[120:121], v[120:121], v[132:133]
    v_pk_add_f32 v[122:123], v[122:123], v[134:135]
    v_pk_mul_f32 v[124:125], v[124:125], v[86:87] op_sel_hi:[1,0]
    v_pk_mul_f32 v[126:127], v[126:127], v[86:87] op_sel_hi:[1,0]
    v_pk_mul_f32 v[116:117], v[116:117], v[86:87] op_sel_hi:[1,0]
    v_pk_mul_f32 v[118:119], v[118:119], v[86:87] op_sel_hi:[1,0]
    v_pk_mul_f32 v[120:121], v[120:121], v[86:87] op_sel_hi:[1,0]
    v_pk_mul_f32 v[122:123], v[122:123], v[86:87] op_sel_hi:[1,0]
    v_cmp_u_f32 s[50:51], v116, v116
    v_cvt_pk_bf16_f32 v132, v124, v125
    v_cvt_pk_bf16_f32 v133, v126, v127
    v_cvt_pk_bf16_f32 v128, v116, v117
    v_cvt_pk_bf16_f32 v129, v118, v119
    v_cvt_pk_bf16_f32 v130, v120, v121
    v_cvt_pk_bf16_f32 v131, v122, v123
    s_or_b64 vcc, vcc, s[50:51]
    s_or_b32 s47, vcc_lo, vcc_hi
    v_mov_b32_dpp v134, v132 quad_perm:[1,1,3,3] row_mask:0xf bank_mask:0xf
    v_mov_b32_dpp v135, v133 quad_perm:[1,1,3,3] row_mask:0xf bank_mask:0xf
    s_cmp_lg_u32 s58, 0
    s_cselect_b32 s47, 0, s47
    s_cselect_b32 s48, s63, s47
    s_cmp_lg_u32 s48, 0
    s_cbranch_scc1 F_NOST
    buffer_store_dwordx4 v[128:131], v5, s[40:43], s60 offen sc1
    s_mov_b32 exec_lo, 0x55555555
    s_mov_b32 exec_hi, 0x0
    buffer_store_dwordx4 v[132:135], v6, s[40:43], s60 offen offset:1024 sc1
    s_mov_b64 exec, -1
F_NOST:
    s_cmp_eq_u32 s47, 0
    s_cselect_b32 s63, 1, 0
    s_lshl_b32 s48, s44, 2
    v_mov_b32 v1, s48
    v_mov_b32 v2, s47
    ds_write_b32 v1, v2 offset:32
    v_mov_b32 v1, 0
    s_waitcnt vmcnt(0) lgkmcnt(0)
    s_barrier
    ds_read_b128 v[84:87], v1 offset:32
    ds_read_b128 v[88:91], v1 offset:48
    s_waitcnt lgkmcnt(0)
    v_or3_b32 v84, v84, v85, v86
    v_or3_b32 v87, v87, v88, v89
    v_or3_b32 v84, v84, v90, v91
    v_or_b32 v84, v84, v87
    s_nop 0
    v_readfirstlane_b32 s47, v84
    s_cmp_lg_u32 s47, 0
    s_cbranch_scc1 F_FB
    s_endpgm
F_FB:
    s_mov_b32 s58, 1
    v_mov_b32 v40, 0xff800000
    v_mov_b32 v41, 0xff800000
    v_mov_b32 v42, 0xff800000
    v_mov_b32 v43, 0xff800000
    s_mov_b32 s55, s59
    s_mov_b32 s57, 0
F_FB1:
    s_addk_i32 s55, 3072
    buffer_load_dwordx4 v[36:39], v5, s[40:43], s55 offen sc1
    buffer_load_dwordx2 v[10:11], v6, s[40:43], s55 offen offset:2560 sc1
    s_waitcnt vmcnt(0)
    v_mfma_f32_32x32x16_bf16 v[84:99], v[36:39], v[12:15], 0
    v_mfma_f32_32x32x8_bf16 v[84:99], v[10:11], v[28:29], v[84:99]
    s_nop 7
    s_nop 7
    v_max3_f32 v40, v40, v84, v85
    v_max3_f32 v40, v40, v86, v87
    v_max3_f32 v40, v40, v88, v89
    v_max3_f32 v40, v40, v90, v91
    v_max3_f32 v40, v40, v92, v93
    v_max3_f32 v40, v40, v94, v95
    v_max3_f32 v40, v40, v96, v97
    v_max3_f32 v40, v40, v98, v99
    v_mfma_f32_32x32x16_bf16 v[84:99], v[36:39], v[16:19], 0
    v_mfma_f32_32x32x8_bf16 v[84:99], v[10:11], v[30:31], v[84:99]
    s_nop 7
    s_nop 7
    v_max3_f32 v41, v41, v84, v85
    v_max3_f32 v41, v41, v86, v87
    v_max3_f32 v41, v41, v88, v89
    v_max3_f32 v41, v41, v90, v91
    v_max3_f32 v41, v41, v92, v93
    v_max3_f32 v41, v41, v94, v95
    v_max3_f32 v41, v41, v96, v97
    v_max3_f32 v41, v41, v98, v99
    v_mfma_f32_32x32x16_bf16 v[84:99], v[36:39], v[20:23], 0
    v_mfma_f32_32x32x8_bf16 v[84:99], v[10:11], v[32:33], v[84:99]
    s_nop 7
    s_nop 7
    v_max3_f32 v42, v42, v84, v85
    v_max3_f32 v42, v42, v86, v87
    v_max3_f32 v42, v42, v88, v89
    v_max3_f32 v42, v42, v90, v91
    v_max3_f32 v42, v42, v92, v93
    v_max3_f32 v42, v42, v94, v95
    v_max3_f32 v42, v42, v96, v97
    v_max3_f32 v42, v42, v98, v99
    v_mfma_f32_32x32x16_bf16 v[84:99], v[36:39], v[24:27], 0
    v_mfma_f32_32x32x8_bf16 v[84:99], v[10:11], v[34:35], v[84:99]
    s_nop 7
    s_nop 7
    v_max3_f32 v43, v43, v84, v85
    v_max3_f32 v43, v43, v86, v87
    v_max3_f32 v43, v43, v88, v89
    v_max3_f32 v43, v43, v90, v91
    v_max3_f32 v43, v43, v92, v93
    v_max3_f32 v43, v43, v94, v95
    v_max3_f32 v43, v43, v96, v97
    v_max3_f32 v43, v43, v98, v99
    s_add_u32 s57, s57, 1
    s_cmp_lt_u32 s57, 16
    s_cbranch_scc1 F_FB1
    v_and_b32 v3, 31, v0
    v_lshlrev_b32 v3, 4, v3
    v_mov_b32 v1, v40
    s_nop 1
    v_permlane32_swap_b32 v1, v40
    s_lshl_b32 s47, s54, 2
    s_add_u32 s47, s47, s64
    v_max_f32 v40, v40, v1
    s_lshl_b32 s47, s47, 9
    s_add_u32 s47, s47, 512
    v_add_u32 v100, s47, v3
    s_lshl_b32 s48, s53, 2
    v_add_u32 v2, s48, v100
    ds_write_b32 v2, v40
    v_mov_b32 v1, v41
    s_nop 1
    v_permlane32_swap_b32 v1, v41
    s_lshl_b32 s47, s54, 2
    s_add_u32 s47, s47, s65
    v_max_f32 v41, v41, v1
    s_lshl_b32 s47, s47, 9
    s_add_u32 s47, s47, 512
    v_add_u32 v101, s47, v3
    s_lshl_b32 s48, s53, 2
    v_add_u32 v2, s48, v101
    ds_write_b32 v2, v41
    v_mov_b32 v1, v42
    s_nop 1
    v_permlane32_swap_b32 v1, v42
    s_lshl_b32 s47, s54, 2
    s_add_u32 s47, s47, s66
    v_max_f32 v42, v42, v1
    s_lshl_b32 s47, s47, 9
    s_add_u32 s47, s47, 512
    v_add_u32 v102, s47, v3
    s_lshl_b32 s48, s53, 2
    v_add_u32 v2, s48, v102
    ds_write_b32 v2, v42
    v_mov_b32 v1, v43
    s_nop 1
    v_permlane32_swap_b32 v1, v43
    s_lshl_b32 s47, s54, 2
    s_add_u32 s47, s47, s67
    v_max_f32 v43, v43, v1
    s_lshl_b32 s47, s47, 9
    s_add_u32 s47, s47, 512
    v_add_u32 v103, s47, v3
    s_lshl_b32 s48, s53, 2
    v_add_u32 v2, s48, v103
    ds_write_b32 v2, v43
    s_waitcnt lgkmcnt(0)
    s_barrier
    ds_read_b128 v[84:87], v100
    ds_read_b128 v[88:91], v101
    ds_read_b128 v[92:95], v102
    ds_read_b128 v[96:99], v103
    s_waitcnt lgkmcnt(0)
    v_max3_f32 v40, v84, v85, v86
    v_max_f32 v40, v40, v87
    v_max3_f32 v41, v88, v89, v90
    v_max_f32 v41, v41, v91
    v_max3_f32 v42, v92, v93, v94
    v_max_f32 v42, v42, v95
    v_max3_f32 v43, v96, v97, v98
    v_max_f32 v43, v43, v99
    v_mov_b32 v116, 0
    v_mov_b32 v117, 0
    v_mov_b32 v118, 0
    v_mov_b32 v119, 0
    v_mov_b32 v120, 0
    v_mov_b32 v121, 0
    v_mov_b32 v122, 0
    v_mov_b32 v123, 0
    v_mov_b32 v124, 0
    v_mov_b32 v125, 0
    v_mov_b32 v126, 0
    v_mov_b32 v127, 0
    v_mov_b32 v128, 0
    v_mov_b32 v129, 0
    v_mov_b32 v130, 0
    v_mov_b32 v131, 0
    v_mov_b32 v132, 0
    v_mov_b32 v133, 0
    v_mov_b32 v134, 0
    v_mov_b32 v135, 0
    v_mov_b32 v136, 0
    v_mov_b32 v137, 0
    v_mov_b32 v138, 0
    v_mov_b32 v139, 0
    v_mov_b32 v140, 0
    v_mov_b32 v141, 0
    v_mov_b32 v142, 0
    v_mov_b32 v143, 0
    v_mov_b32 v144, 0
    v_mov_b32 v145, 0
    v_mov_b32 v146, 0
    v_mov_b32 v147, 0
    v_mov_b32 v148, 0
    v_mov_b32 v149, 0
    v_mov_b32 v150, 0
    v_mov_b32 v151, 0
    v_mov_b32 v152, 0
    v_mov_b32 v153, 0
    v_mov_b32 v154, 0
    v_mov_b32 v155, 0
    v_mov_b32 v156, 0
    v_mov_b32 v157, 0
    v_mov_b32 v158, 0
    v_mov_b32 v159, 0
    v_mov_b32 v160, 0
    v_mov_b32 v161, 0
    v_mov_b32 v162, 0
    v_mov_b32 v163, 0
    s_mov_b32 s55, s59
    s_mov_b32 s56, s59
    s_mov_b32 s57, 0
F_FB2:
    s_addk_i32 s55, 3072
    buffer_load_dwordx4 v[36:39], v5, s[40:43], s55 offen sc1
    buffer_load_dwordx2 v[10:11], v6, s[40:43], s55 offen offset:2560 sc1
    s_addk_i32 s56, 3072
    buffer_load_dwordx4 v[52:55], v7, s[40:43], s56 offen offset:1024 sc1
    buffer_load_dwordx4 v[64:67], v7, s[40:43], s56 offen offset:1792 sc1
    s_waitcnt vmcnt(0)
    v_mfma_f32_32x32x16_bf16 v[84:99], v[36:39], v[12:15], 0
    v_mfma_f32_32x32x8_bf16 v[84:99], v[10:11], v[28:29], v[84:99]
    s_nop 7
    s_nop 7
    v_sub_f32 v84, v84, v40
    v_sub_f32 v85, v85, v40
    v_sub_f32 v86, v86, v40
    v_sub_f32 v87, v87, v40
    v_sub_f32 v88, v88, v40
    v_sub_f32 v89, v89, v40
    v_sub_f32 v90, v90, v40
    v_sub_f32 v91, v91, v40
    v_sub_f32 v92, v92, v40
    v_sub_f32 v93, v93, v40
    v_sub_f32 v94, v94, v40
    v_sub_f32 v95, v95, v40
    v_sub_f32 v96, v96, v40
    v_sub_f32 v97, v97, v40
    v_sub_f32 v98, v98, v40
    v_sub_f32 v99, v99, v40
    v_exp_f32 v84, v84
    v_exp_f32 v85, v85
    v_exp_f32 v86, v86
    v_exp_f32 v87, v87
    v_cvt_pk_bf16_f32 v76, v84, v85
    v_cvt_pk_bf16_f32 v77, v86, v87
    v_exp_f32 v88, v88
    v_exp_f32 v89, v89
    v_exp_f32 v90, v90
    v_exp_f32 v91, v91
    v_cvt_pk_bf16_f32 v78, v88, v89
    v_cvt_pk_bf16_f32 v79, v90, v91
    v_exp_f32 v92, v92
    v_exp_f32 v93, v93
    v_exp_f32 v94, v94
    v_exp_f32 v95, v95
    v_cvt_pk_bf16_f32 v80, v92, v93
    v_cvt_pk_bf16_f32 v81, v94, v95
    v_exp_f32 v96, v96
    v_exp_f32 v97, v97
    v_exp_f32 v98, v98
    v_exp_f32 v99, v99
    v_cvt_pk_bf16_f32 v82, v96, v97
    v_cvt_pk_bf16_f32 v83, v98, v99
    s_nop 1
    v_mfma_f32_32x32x16_bf16 v[116:131], v[52:55], v[76:79], v[116:131]
    v_mfma_f32_32x32x16_bf16 v[116:131], v[64:67], v[80:83], v[116:131]
    v_mfma_f32_32x32x16_bf16 v[84:99], v[36:39], v[16:19], 0
    v_mfma_f32_32x32x8_bf16 v[84:99], v[10:11], v[30:31], v[84:99]
    s_nop 7
    s_nop 7
    v_sub_f32 v84, v84, v41
    v_sub_f32 v85, v85, v41
    v_sub_f32 v86, v86, v41
    v_sub_f32 v87, v87, v41
    v_sub_f32 v88, v88, v41
    v_sub_f32 v89, v89, v41
    v_sub_f32 v90, v90, v41
    v_sub_f32 v91, v91, v41
    v_sub_f32 v92, v92, v41
    v_sub_f32 v93, v93, v41
    v_sub_f32 v94, v94, v41
    v_sub_f32 v95, v95, v41
    v_sub_f32 v96, v96, v41
    v_sub_f32 v97, v97, v41
    v_sub_f32 v98, v98, v41
    v_sub_f32 v99, v99, v41
    v_exp_f32 v84, v84
    v_exp_f32 v85, v85
    v_exp_f32 v86, v86
    v_exp_f32 v87, v87
    v_cvt_pk_bf16_f32 v76, v84, v85
    v_cvt_pk_bf16_f32 v77, v86, v87
    v_exp_f32 v88, v88
    v_exp_f32 v89, v89
    v_exp_f32 v90, v90
    v_exp_f32 v91, v91
    v_cvt_pk_bf16_f32 v78, v88, v89
    v_cvt_pk_bf16_f32 v79, v90, v91
    v_exp_f32 v92, v92
    v_exp_f32 v93, v93
    v_exp_f32 v94, v94
    v_exp_f32 v95, v95
    v_cvt_pk_bf16_f32 v80, v92, v93
    v_cvt_pk_bf16_f32 v81, v94, v95
    v_exp_f32 v96, v96
    v_exp_f32 v97, v97
    v_exp_f32 v98, v98
    v_exp_f32 v99, v99
    v_cvt_pk_bf16_f32 v82, v96, v97
    v_cvt_pk_bf16_f32 v83, v98, v99
    s_nop 1
    v_mfma_f32_32x32x16_bf16 v[128:143], v[52:55], v[76:79], v[128:143]
    v_mfma_f32_32x32x16_bf16 v[128:143], v[64:67], v[80:83], v[128:143]
    v_mfma_f32_32x32x16_bf16 v[84:99], v[36:39], v[20:23], 0
    v_mfma_f32_32x32x8_bf16 v[84:99], v[10:11], v[32:33], v[84:99]
    s_nop 7
    s_nop 7
    v_sub_f32 v84, v84, v42
    v_sub_f32 v85, v85, v42
    v_sub_f32 v86, v86, v42
    v_sub_f32 v87, v87, v42
    v_sub_f32 v88, v88, v42
    v_sub_f32 v89, v89, v42
    v_sub_f32 v90, v90, v42
    v_sub_f32 v91, v91, v42
    v_sub_f32 v92, v92, v42
    v_sub_f32 v93, v93, v42
    v_sub_f32 v94, v94, v42
    v_sub_f32 v95, v95, v42
    v_sub_f32 v96, v96, v42
    v_sub_f32 v97, v97, v42
    v_sub_f32 v98, v98, v42
    v_sub_f32 v99, v99, v42
    v_exp_f32 v84, v84
    v_exp_f32 v85, v85
    v_exp_f32 v86, v86
    v_exp_f32 v87, v87
    v_cvt_pk_bf16_f32 v76, v84, v85
    v_cvt_pk_bf16_f32 v77, v86, v87
    v_exp_f32 v88, v88
    v_exp_f32 v89, v89
    v_exp_f32 v90, v90
    v_exp_f32 v91, v91
    v_cvt_pk_bf16_f32 v78, v88, v89
    v_cvt_pk_bf16_f32 v79, v90, v91
    v_exp_f32 v92, v92
    v_exp_f32 v93, v93
    v_exp_f32 v94, v94
    v_exp_f32 v95, v95
    v_cvt_pk_bf16_f32 v80, v92, v93
    v_cvt_pk_bf16_f32 v81, v94, v95
    v_exp_f32 v96, v96
    v_exp_f32 v97, v97
    v_exp_f32 v98, v98
    v_exp_f32 v99, v99
    v_cvt_pk_bf16_f32 v82, v96, v97
    v_cvt_pk_bf16_f32 v83, v98, v99
    s_nop 1
    v_mfma_f32_32x32x16_bf16 v[140:155], v[52:55], v[76:79], v[140:155]
    v_mfma_f32_32x32x16_bf16 v[140:155], v[64:67], v[80:83], v[140:155]
    v_mfma_f32_32x32x16_bf16 v[84:99], v[36:39], v[24:27], 0
    v_mfma_f32_32x32x8_bf16 v[84:99], v[10:11], v[34:35], v[84:99]
    s_nop 7
    s_nop 7
    v_sub_f32 v84, v84, v43
    v_sub_f32 v85, v85, v43
    v_sub_f32 v86, v86, v43
    v_sub_f32 v87, v87, v43
    v_sub_f32 v88, v88, v43
    v_sub_f32 v89, v89, v43
    v_sub_f32 v90, v90, v43
    v_sub_f32 v91, v91, v43
    v_sub_f32 v92, v92, v43
    v_sub_f32 v93, v93, v43
    v_sub_f32 v94, v94, v43
    v_sub_f32 v95, v95, v43
    v_sub_f32 v96, v96, v43
    v_sub_f32 v97, v97, v43
    v_sub_f32 v98, v98, v43
    v_sub_f32 v99, v99, v43
    v_exp_f32 v84, v84
    v_exp_f32 v85, v85
    v_exp_f32 v86, v86
    v_exp_f32 v87, v87
    v_cvt_pk_bf16_f32 v76, v84, v85
    v_cvt_pk_bf16_f32 v77, v86, v87
    v_exp_f32 v88, v88
    v_exp_f32 v89, v89
    v_exp_f32 v90, v90
    v_exp_f32 v91, v91
    v_cvt_pk_bf16_f32 v78, v88, v89
    v_cvt_pk_bf16_f32 v79, v90, v91
    v_exp_f32 v92, v92
    v_exp_f32 v93, v93
    v_exp_f32 v94, v94
    v_exp_f32 v95, v95
    v_cvt_pk_bf16_f32 v80, v92, v93
    v_cvt_pk_bf16_f32 v81, v94, v95
    v_exp_f32 v96, v96
    v_exp_f32 v97, v97
    v_exp_f32 v98, v98
    v_exp_f32 v99, v99
    v_cvt_pk_bf16_f32 v82, v96, v97
    v_cvt_pk_bf16_f32 v83, v98, v99
    s_nop 1
    v_mfma_f32_32x32x16_bf16 v[152:167], v[52:55], v[76:79], v[152:167]
    v_mfma_f32_32x32x16_bf16 v[152:167], v[64:67], v[80:83], v[152:167]
    s_add_u32 s57, s57, 1
    s_cmp_lt_u32 s57, 16
    s_cbranch_scc1 F_FB2
    s_nop 7
    s_nop 7
    s_lshl_b32 s47, s64, 1
    s_add_u32 s47, s47, s54
    s_mul_i32 s47, s47, 9216
    s_add_u32 s47, s47, 8192
    v_add_u32 v8, s47, v5
    ds_write_b128 v8, v[116:119]
    ds_write_b128 v8, v[120:123] offset:1024
    ds_write_b128 v8, v[124:127] offset:2048
    s_lshl_b32 s47, s65, 1
    s_add_u32 s47, s47, s54
    s_mul_i32 s47, s47, 9216
    s_add_u32 s47, s47, 11264
    v_add_u32 v8, s47, v5
    ds_write_b128 v8, v[128:131]
    ds_write_b128 v8, v[132:135] offset:1024
    ds_write_b128 v8, v[136:139] offset:2048
    s_lshl_b32 s47, s66, 1
    s_add_u32 s47, s47, s54
    s_mul_i32 s47, s47, 9216
    s_add_u32 s47, s47, 14336
    v_add_u32 v8, s47, v5
    ds_write_b128 v8, v[140:143]
    ds_write_b128 v8, v[144:147] offset:1024
    ds_write_b128 v8, v[148:151] offset:2048
    s_mul_i32 s47, s44, 9216
    s_add_u32 s47, s47, 8192
    s_branch F_RED
F_PREP:
    s_lshl_b32 s54, s46, 2
    s_add_u32 s54, s54, s53
    s_mul_i32 s50, s46, 160
    v_add_u32 v1, 0, v0
    v_mul_u32_u24 v2, 6554, v1
    v_lshrrev_b32 v2, 16, v2
    v_mul_u32_u24 v3, 10, v2
    v_sub_u32 v1, v1, v3
    v_lshl_add_u32 v1, v1, 4, s50
    v_lshrrev_b32 v3, 4, v2
    v_bfe_u32 v4, v2, 3, 1
    v_and_b32 v2, 7, v2
    v_lshl_add_u32 v2, v3, 3, v2
    v_mad_u32_u24 v2, v4, 20, v2
    v_mul_u32_u24 v2, 1280, v2
    v_add_u32 v128, v2, v1
    v_add_u32 v1, 64, v0
    v_mul_u32_u24 v2, 6554, v1
    v_lshrrev_b32 v2, 16, v2
    v_mul_u32_u24 v3, 10, v2
    v_sub_u32 v1, v1, v3
    v_lshl_add_u32 v1, v1, 4, s50
    v_subrev_u32 v1, 1024, v1
    v_lshrrev_b32 v3, 4, v2
    v_bfe_u32 v4, v2, 3, 1
    v_and_b32 v2, 7, v2
    v_lshl_add_u32 v2, v3, 3, v2
    v_mad_u32_u24 v2, v4, 20, v2
    v_mul_u32_u24 v2, 1280, v2
    v_add_u32 v129, v2, v1
    v_add_u32 v1, 128, v0
    v_mul_u32_u24 v2, 6554, v1
    v_lshrrev_b32 v2, 16, v2
    v_mul_u32_u24 v3, 10, v2
    v_sub_u32 v1, v1, v3
    v_lshl_add_u32 v1, v1, 4, s50
    v_subrev_u32 v1, 2048, v1
    v_lshrrev_b32 v3, 4, v2
    v_bfe_u32 v4, v2, 3, 1
    v_and_b32 v2, 7, v2
    v_lshl_add_u32 v2, v3, 3, v2
    v_mad_u32_u24 v2, v4, 20, v2
    v_mul_u32_u24 v2, 1280, v2
    v_add_u32 v130, v2, v1
    v_add_u32 v1, 192, v0
    v_mul_u32_u24 v2, 6554, v1
    v_lshrrev_b32 v2, 16, v2
    v_mul_u32_u24 v3, 10, v2
    v_sub_u32 v1, v1, v3
    v_lshl_add_u32 v1, v1, 4, s50
    v_subrev_u32 v1, 3072, v1
    v_lshrrev_b32 v3, 4, v2
    v_bfe_u32 v4, v2, 3, 1
    v_and_b32 v2, 7, v2
    v_lshl_add_u32 v2, v3, 3, v2
    v_mad_u32_u24 v2, v4, 20, v2
    v_mul_u32_u24 v2, 1280, v2
    v_add_u32 v131, v2, v1
    v_add_u32 v1, 256, v0
    v_mul_u32_u24 v2, 6554, v1
    v_lshrrev_b32 v2, 16, v2
    v_mul_u32_u24 v3, 10, v2
    v_sub_u32 v1, v1, v3
    v_lshl_add_u32 v1, v1, 4, s50
    v_lshrrev_b32 v3, 4, v2
    v_bfe_u32 v4, v2, 3, 1
    v_and_b32 v2, 7, v2
    v_lshl_add_u32 v2, v3, 3, v2
    v_mad_u32_u24 v2, v4, 20, v2
    v_mul_u32_u24 v2, 1280, v2
    v_add_u32 v132, v2, v1
    s_cmp_lg_u32 s53, 3
    s_cbranch_scc1 F_EB7
    s_barrier
F_EB7:
    s_cmp_lg_u32 s53, 3
    s_cbranch_scc1 F_EB8
    s_barrier
F_EB8:
    s_cmp_lg_u32 s53, 3
    s_cbranch_scc1 F_EB9
    s_barrier
    v_mov_b32 v22, 0
    s_mov_b64 exec, 1
    s_lshl_b32 s47, s2, 6
    s_add_u32 s47, s47, 278528
    buffer_store_dword v21, v22, s[40:43], s47 offen sc1
    ds_write_b32 v22, v21 offset:12
    s_mov_b64 exec, -1
F_EB9:
    v_mov_b32 v9, 0
    v_mov_b32 v8, 1
    v_lshlrev_b32 v20, 6, v0
    s_cmp_lg_u32 s53, 3
    s_cbranch_scc1 F_EB10
    s_barrier
F_EB10:
    v_and_b32 v1, 31, v0
    v_lshrrev_b32 v2, 5, v0
    v_bfe_u32 v3, v0, 1, 3
    v_xor_b32 v2, v2, v3
    v_lshlrev_b32 v1, 7, v1
    v_lshl_add_u32 v1, v2, 4, v1
    v_xor_b32 v10, 0, v1
    v_add_u32 v10, 512, v10
    v_xor_b32 v11, 32, v1
    v_add_u32 v11, 512, v11
    v_xor_b32 v12, 64, v1
    v_add_u32 v12, 512, v12
    v_xor_b32 v13, 96, v1
    v_add_u32 v13, 512, v13
    v_and_b32 v1, 7, v0
    v_lshrrev_b32 v2, 5, v0
    v_lshl_add_u32 v1, v2, 3, v1
    v_lshlrev_b32 v133, 4, v1
    v_lshlrev_b32 v134, 3, v1
    v_and_b32 v3, 31, v0
    v_lshlrev_b32 v1, 3, v3
    v_lshl_add_u32 v6, v2, 30, v1
    v_lshrrev_b32 v2, 5, v0
    s_mul_i32 s49, s53, 1920
    s_add_u32 s49, s49, 512
    v_and_b32 v3, 31, v0
    v_mul_u32_u24 v1, 48, v3
    v_lshl_add_u32 v1, v2, 3, v1
    v_add_u32 v141, s49, v1
    v_lshlrev_b32 v3, 4, v2
    v_sub_u32 v142, v141, v3
    v_bfe_u32 v3, v0, 2, 2
    v_lshl_add_u32 v1, v2, 2, v3
    v_mul_u32_u24 v1, 48, v1
    v_bfe_u32 v2, v0, 4, 1
    v_and_b32 v3, 3, v0
    v_lshl_add_u32 v2, v2, 2, v3
    v_min_u32 v2, 5, v2
    v_lshl_add_u32 v1, v2, 3, v1
    v_add_u32 v5, s49, v1
    s_lshr_b32 s47, s53, 1
    s_mul_i32 s48, s47, 5120
    s_add_u32 s48, s48, 81920
    v_lshrrev_b32 v1, 2, v0
    v_mul_u32_u24 v1, 160, v1
    v_lshl_add_u32 v1, v3, 3, v1
    v_add_u32 v143, s48, v1
    v_lshrrev_b32 v1, 4, v0
    v_lshrrev_b32 v2, 5, v0
    v_add_u32 v1, v1, v2
    v_lshl_add_u32 v135, v1, 8, v7
    s_and_b32 s48, s53, 1
    s_lshl_b32 s49, s45, 1
    s_add_u32 s48, s48, s49
    s_mul_i32 s48, s48, 40960
    s_add_u32 s65, s48, 8912896
    s_lshl_b32 s47, s45, 6
    s_add_u32 s48, s47, s54
    s_mul_i32 s48, s48, 1280
    s_add_u32 s62, s48, 8912896
    s_lshl_b32 s47, s45, 5
    s_add_u32 s67, s47, s54
    s_mul_i32 s56, s54, 81920
    s_add_u32 s56, s56, 3145728
    s_mov_b32 s57, 0
    s_mov_b32 s60, 0x3ea52b5c
    s_mov_b32 s32, s18
    s_and_b32 s33, s19, 0xffff
    s_mov_b32 s34, 819200
    s_mov_b32 s35, 0x00020000
    s_cmp_lg_u32 s53, 3
    s_cbranch_scc1 F_EB11
    s_barrier
    s_branch F_H0
F_EB11:
    s_add_u32 m0, s4, s10
    s_add_u32 s48, s7, s11
    buffer_load_dwordx4 v24, s[28:31], s48 offen lds
    buffer_load_dwordx4 v25, s[28:31], s48 offen offset:1024 lds
    s_add_u32 m0, s5, s10
    s_add_u32 s48, s8, s11
    buffer_load_dwordx4 v26, s[28:31], s48 offen lds
    buffer_load_dwordx4 v27, s[28:31], s48 offen offset:1024 lds
    s_add_u32 m0, s6, s10
    s_add_u32 s48, s9, s11
    buffer_load_dwordx4 v28, s[28:31], s48 offen lds
    s_cmp_lg_u32 s53, 0
    s_cbranch_scc1 F_IS12
    buffer_load_dwordx4 v29, s[28:31], s48 offen offset:1024 lds
F_IS12:
    s_add_u32 s10, s10, s14
    s_cmp_eq_u32 s10, s15
    s_cselect_b32 s10, 0, s10
    s_add_u32 s11, s11, s16
    s_add_u32 m0, s4, s10
    s_add_u32 s48, s7, s11
    buffer_load_dwordx4 v24, s[28:31], s48 offen lds
    buffer_load_dwordx4 v25, s[28:31], s48 offen offset:1024 lds
    s_add_u32 m0, s5, s10
    s_add_u32 s48, s8, s11
    buffer_load_dwordx4 v26, s[28:31], s48 offen lds
    buffer_load_dwordx4 v27, s[28:31], s48 offen offset:1024 lds
    s_add_u32 m0, s6, s10
    s_add_u32 s48, s9, s11
    buffer_load_dwordx4 v28, s[28:31], s48 offen lds
    s_cmp_lg_u32 s53, 0
    s_cbranch_scc1 F_IS13
    buffer_load_dwordx4 v29, s[28:31], s48 offen offset:1024 lds
F_IS13:
    s_add_u32 s10, s10, s14
    s_cmp_eq_u32 s10, s15
    s_cselect_b32 s10, 0, s10
    s_add_u32 s11, s11, s16
    s_barrier
    s_waitcnt vmcnt(10)
    s_barrier
    s_add_u32 m0, s4, s10
    s_add_u32 s48, s7, s11
    buffer_load_dwordx4 v24, s[28:31], s48 offen lds
    buffer_load_dwordx4 v25, s[28:31], s48 offen offset:1024 lds
    s_add_u32 m0, s5, s10
    s_add_u32 s48, s8, s11
    buffer_load_dwordx4 v26, s[28:31], s48 offen lds
    buffer_load_dwordx4 v27, s[28:31], s48 offen offset:1024 lds
    s_add_u32 m0, s6, s10
    s_add_u32 s48, s9, s11
    buffer_load_dwordx4 v28, s[28:31], s48 offen lds
    s_cmp_lg_u32 s53, 0
    s_cbranch_scc1 F_IS14
    buffer_load_dwordx4 v29, s[28:31], s48 offen offset:1024 lds
F_IS14:
    s_add_u32 s10, s10, s14
    s_cmp_eq_u32 s10, s15
    s_cselect_b32 s10, 0, s10
    s_add_u32 s11, s11, s16
    s_add_u32 m0, s4, s10
    s_add_u32 s48, s7, s11
    buffer_load_dwordx4 v24, s[28:31], s48 offen lds
    buffer_load_dwordx4 v25, s[28:31], s48 offen offset:1024 lds
    s_add_u32 m0, s5, s10
    s_add_u32 s48, s8, s11
    buffer_load_dwordx4 v26, s[28:31], s48 offen lds
    buffer_load_dwordx4 v27, s[28:31], s48 offen offset:1024 lds
    s_add_u32 m0, s6, s10
    s_add_u32 s48, s9, s11
    buffer_load_dwordx4 v28, s[28:31], s48 offen lds
    s_cmp_lg_u32 s53, 0
    s_cbranch_scc1 F_IS15
    buffer_load_dwordx4 v29, s[28:31], s48 offen offset:1024 lds
F_IS15:
    s_add_u32 s10, s10, s14
    s_cmp_eq_u32 s10, s15
    s_cselect_b32 s10, 0, s10
    s_add_u32 s11, s11, s16
    s_waitcnt vmcnt(15)
    s_barrier
    s_add_u32 m0, s4, s10
    s_add_u32 s48, s7, s11
    buffer_load_dwordx4 v24, s[28:31], s48 offen lds
    buffer_load_dwordx4 v25, s[28:31], s48 offen offset:1024 lds
    s_add_u32 m0, s5, s10
    s_add_u32 s48, s8, s11
    buffer_load_dwordx4 v26, s[28:31], s48 offen lds
    buffer_load_dwordx4 v27, s[28:31], s48 offen offset:1024 lds
    s_add_u32 m0, s6, s10
    s_add_u32 s48, s9, s11
    buffer_load_dwordx4 v28, s[28:31], s48 offen lds
    s_cmp_lg_u32 s53, 0
    s_cbranch_scc1 F_IS16
    buffer_load_dwordx4 v29, s[28:31], s48 offen offset:1024 lds
F_IS16:
    s_add_u32 s10, s10, s14
    s_cmp_eq_u32 s10, s15
    s_cselect_b32 s10, 0, s10
    s_add_u32 s11, s11, s16
    s_mov_b32 s61, 0
F_LL:
    s_add_u32 m0, s4, s10
    s_add_u32 s48, s7, s11
    buffer_load_dwordx4 v24, s[28:31], s48 offen lds
    buffer_load_dwordx4 v25, s[28:31], s48 offen offset:1024 lds
    s_add_u32 m0, s5, s10
    s_add_u32 s48, s8, s11
    buffer_load_dwordx4 v26, s[28:31], s48 offen lds
    buffer_load_dwordx4 v27, s[28:31], s48 offen offset:1024 lds
    s_add_u32 m0, s6, s10
    s_add_u32 s48, s9, s11
    buffer_load_dwordx4 v28, s[28:31], s48 offen lds
    s_cmp_lg_u32 s53, 0
    s_cbranch_scc1 F_IS17
    buffer_load_dwordx4 v29, s[28:31], s48 offen offset:1024 lds
F_IS17:
    s_add_u32 s10, s10, s14
    s_cmp_eq_u32 s10, s15
    s_cselect_b32 s10, 0, s10
    s_add_u32 s11, s11, s16
    s_waitcnt vmcnt(20)
    s_barrier
    s_add_u32 s61, s61, 1
    s_cmp_lt_u32 s61, 4
    s_cbranch_scc1 F_LL
    s_waitcnt vmcnt(15) lgkmcnt(0)
    s_barrier
    ds_read_b32 v21, v9 offset:12
    s_waitcnt vmcnt(10) lgkmcnt(0)
    s_barrier
    s_waitcnt vmcnt(5) lgkmcnt(0)
    s_barrier
    s_waitcnt vmcnt(0) lgkmcnt(0)
    s_barrier
    v_readfirstlane_b32 s55, v21
    s_branch F_H4
F_H0:
    s_barrier
    s_mov_b32 s47, 262144
    buffer_load_dword v16, v20, s[40:43], s47 offen sc1
    s_mov_b32 s47, 266240
    buffer_load_dword v17, v20, s[40:43], s47 offen sc1
    s_mov_b32 s47, 270336
    buffer_load_dword v18, v20, s[40:43], s47 offen sc1
    s_mov_b32 s47, 274432
    buffer_load_dword v19, v20, s[40:43], s47 offen sc1
    s_barrier
    s_barrier
    s_mov_b32 s48, 0
    s_waitcnt vmcnt(0)
F_E_POLL:
    v_xor_b32 v16, s55, v16
    v_xor_b32 v17, s55, v17
    v_xor_b32 v18, s55, v18
    v_xor_b32 v19, s55, v19
    v_or3_b32 v16, v16, v17, v18
    v_or_b32 v16, v16, v19
    v_cmp_ne_u32 vcc, 0, v16
    s_add_u32 s48, s48, 1
    s_cbranch_vccz F_E_OK
    s_cmp_ge_u32 s48, 65536
    s_cbranch_scc1 F_E_OK
    s_mov_b32 s47, 262144
    buffer_load_dword v16, v20, s[40:43], s47 offen sc1
    s_mov_b32 s47, 266240
    buffer_load_dword v17, v20, s[40:43], s47 offen sc1
    s_mov_b32 s47, 270336
    buffer_load_dword v18, v20, s[40:43], s47 offen sc1
    s_mov_b32 s47, 274432
    buffer_load_dword v19, v20, s[40:43], s47 offen sc1
    s_waitcnt vmcnt(0)
    s_branch F_E_POLL
F_E_OK:
    s_barrier
    s_lshr_b32 s47, s2, 3
    s_mul_i32 s47, s47, 6144
    v_lshlrev_b32 v1, 7, v0
    s_mov_b32 exec_lo, 0xffffffff
    s_mov_b32 exec_hi, 0xffff
    buffer_load_dword v144, v1, s[40:43], s47 offen sc1
    s_mov_b64 exec, -1
F_H4:
    s_setprio 3
F_H5:
    s_mul_i32 s58, s53, 5120
    s_add_u32 s58, s58, 81920
    s_mul_i32 s59, s53, 51200
    s_mov_b32 s28, s12
    s_and_b32 s29, s13, 0xffff
    s_mov_b32 s30, 819200
    s_mov_b32 s31, 0x00020000
    s_lshr_b32 s47, s2, 3
    s_lshl_b32 s47, s47, 2
    s_add_u32 s47, s47, s53
    s_mul_i32 s51, s47, 3840
    s_and_b32 s47, s2, 1
    s_mul_i32 s47, s47, 640
    s_add_u32 s51, s51, s47
    s_lshr_b32 s47, s2, 6
    s_lshl_b32 s47, s47, 11
    s_add_u32 s52, s56, s47
    v_mov_b32 v146, 1073741824
    s_mov_b32 exec_lo, 0x7fff
    s_mov_b32 exec_hi, 0x0
    v_mul_u32_u24 v146, 52, v0
    v_lshrrev_b32 v146, 8, v146
    v_mul_u32_u24 v146, 640, v146
    v_lshl_add_u32 v146, v0, 7, v146
    s_mov_b64 exec, -1
    s_mul_i32 s50, s46, 160
    v_add_u32 v1, 0, v0
    v_mul_u32_u24 v2, 6554, v1
    v_lshrrev_b32 v2, 16, v2
    v_mul_u32_u24 v3, 10, v2
    v_sub_u32 v1, v1, v3
    v_lshl_add_u32 v1, v1, 4, s50
    v_lshrrev_b32 v3, 4, v2
    v_bfe_u32 v4, v2, 2, 2
    v_lshl_add_u32 v3, v4, 1, v3
    v_and_b32 v2, 3, v2
    v_mad_u32_u24 v2, v3, 20, v2
    v_add_u32 v2, 16, v2
    v_mul_u32_u24 v2, 1280, v2
    v_add_u32 v136, v2, v1
    v_add_u32 v1, 64, v0
    v_mul_u32_u24 v2, 6554, v1
    v_lshrrev_b32 v2, 16, v2
    v_mul_u32_u24 v3, 10, v2
    v_sub_u32 v1, v1, v3
    v_lshl_add_u32 v1, v1, 4, s50
    v_subrev_u32 v1, 1024, v1
    v_lshrrev_b32 v3, 4, v2
    v_bfe_u32 v4, v2, 2, 2
    v_lshl_add_u32 v3, v4, 1, v3
    v_and_b32 v2, 3, v2
    v_mad_u32_u24 v2, v3, 20, v2
    v_add_u32 v2, 16, v2
    v_mul_u32_u24 v2, 1280, v2
    v_add_u32 v137, v2, v1
    v_add_u32 v1, 128, v0
    v_mul_u32_u24 v2, 6554, v1
    v_lshrrev_b32 v2, 16, v2
    v_mul_u32_u24 v3, 10, v2
    v_sub_u32 v1, v1, v3
    v_lshl_add_u32 v1, v1, 4, s50
    v_subrev_u32 v1, 2048, v1
    v_lshrrev_b32 v3, 4, v2
    v_bfe_u32 v4, v2, 2, 2
    v_lshl_add_u32 v3, v4, 1, v3
    v_and_b32 v2, 3, v2
    v_mad_u32_u24 v2, v3, 20, v2
    v_add_u32 v2, 16, v2
    v_mul_u32_u24 v2, 1280, v2
    v_add_u32 v138, v2, v1
    v_add_u32 v1, 192, v0
    v_mul_u32_u24 v2, 6554, v1
    v_lshrrev_b32 v2, 16, v2
    v_mul_u32_u24 v3, 10, v2
    v_sub_u32 v1, v1, v3
    v_lshl_add_u32 v1, v1, 4, s50
    v_subrev_u32 v1, 3072, v1
    v_lshrrev_b32 v3, 4, v2
    v_bfe_u32 v4, v2, 2, 2
    v_lshl_add_u32 v3, v4, 1, v3
    v_and_b32 v2, 3, v2
    v_mad_u32_u24 v2, v3, 20, v2
    v_add_u32 v2, 16, v2
    v_mul_u32_u24 v2, 1280, v2
    v_add_u32 v139, v2, v1
    v_add_u32 v1, 256, v0
    v_mul_u32_u24 v2, 6554, v1
    v_lshrrev_b32 v2, 16, v2
    v_mul_u32_u24 v3, 10, v2
    v_sub_u32 v1, v1, v3
    v_lshl_add_u32 v1, v1, 4, s50
    v_lshrrev_b32 v3, 4, v2
    v_bfe_u32 v4, v2, 2, 2
    v_lshl_add_u32 v3, v4, 1, v3
    v_and_b32 v2, 3, v2
    v_mad_u32_u24 v2, v3, 20, v2
    v_add_u32 v2, 16, v2
    v_mul_u32_u24 v2, 1280, v2
    v_add_u32 v140, v2, v1
    v_mov_b32 v148, 0xf149f2ca
    v_mov_b32 v149, 0xf149f2ca
    v_mov_b32 v150, 0xf149f2ca
    v_mov_b32 v151, 0xf149f2ca
    v_mov_b32 v152, 0xf149f2ca
    v_mov_b32 v153, 0xf149f2ca
    v_mov_b32 v154, 0xf149f2ca
    v_mov_b32 v155, 0xf149f2ca
    v_mov_b32 v156, 0xf149f2ca
    v_mov_b32 v157, 0xf149f2ca
    v_mov_b32 v158, 0xf149f2ca
    v_mov_b32 v159, 0xf149f2ca
    v_mov_b32 v160, 0xf149f2ca
    v_mov_b32 v161, 0xf149f2ca
    v_mov_b32 v162, 0xf149f2ca
    v_mov_b32 v163, 0xf149f2ca
    v_mov_b32 v164, 0xf149f2ca
    v_mov_b32 v165, 0xf149f2ca
    v_mov_b32 v166, 0xf149f2ca
    v_mov_b32 v167, 0xf149f2ca
    s_mov_b32 exec_lo, 0xff
    s_mov_b32 exec_hi, 0xff0
    v_mov_b32 v148, 0
    s_mov_b32 exec_lo, 0x1fe
    s_mov_b32 exec_hi, 0x1fe0
    v_mov_b32 v149, 0
    s_mov_b32 exec_lo, 0x3fc
    s_mov_b32 exec_hi, 0x3fc0
    v_mov_b32 v150, 0
    s_mov_b32 exec_lo, 0x7f8
    s_mov_b32 exec_hi, 0x7f80
    v_mov_b32 v151, 0
    s_mov_b32 exec_lo, 0xff00
    s_mov_b32 exec_hi, 0xff000
    v_mov_b32 v152, 0
    s_mov_b32 exec_lo, 0x1fe00
    s_mov_b32 exec_hi, 0x1fe000
    v_mov_b32 v153, 0
    s_mov_b32 exec_lo, 0x3fc00
    s_mov_b32 exec_hi, 0x3fc000
    v_mov_b32 v154, 0
    s_mov_b32 exec_lo, 0x7f800
    s_mov_b32 exec_hi, 0x7f8000
    v_mov_b32 v155, 0
    s_mov_b32 exec_lo, 0xff0000
    s_mov_b32 exec_hi, 0xff00000
    v_mov_b32 v156, 0
    s_mov_b32 exec_lo, 0x1fe0000
    s_mov_b32 exec_hi, 0x1fe00000
    v_mov_b32 v157, 0
    s_mov_b32 exec_lo, 0x3fc0000
    s_mov_b32 exec_hi, 0x3fc00000
    v_mov_b32 v158, 0
    s_mov_b32 exec_lo, 0x7f80000
    s_mov_b32 exec_hi, 0x7f800000
    v_mov_b32 v159, 0
    s_mov_b32 exec_lo, 0xff000000
    s_mov_b32 exec_hi, 0xf0000000
    v_mov_b32 v160, 0
    s_mov_b32 exec_lo, 0xfe000000
    s_mov_b32 exec_hi, 0xe0000000
    v_mov_b32 v161, 0
    s_mov_b32 exec_lo, 0xfc000000
    s_mov_b32 exec_hi, 0xc0000000
    v_mov_b32 v162, 0
    s_mov_b32 exec_lo, 0xf8000000
    s_mov_b32 exec_hi, 0x80000000
    v_mov_b32 v163, 0
    s_cmp_eq_u32 s45, 0
    s_cbranch_scc1 F_H3
    s_mov_b32 exec_lo, 0x0
    s_mov_b32 exec_hi, 0xf
    v_mov_b32 v164, 0
    s_mov_b32 exec_lo, 0x1
    s_mov_b32 exec_hi, 0x1f
    v_mov_b32 v165, 0
    s_mov_b32 exec_lo, 0x3
    s_mov_b32 exec_hi, 0x3f
    v_mov_b32 v166, 0
    s_mov_b32 exec_lo, 0x7
    s_mov_b32 exec_hi, 0x7f
    v_mov_b32 v167, 0
F_H3:
    s_mov_b64 exec, -1
    s_barrier
    s_cmp_lg_u32 s53, 3
    s_cbranch_scc1 F_H7
    s_mov_b32 s47, 278528
    buffer_load_dword v16, v20, s[40:43], s47 offen sc1
    s_mov_b32 s47, 282624
    buffer_load_dword v17, v20, s[40:43], s47 offen sc1
    s_mov_b32 s47, 286720
    buffer_load_dword v18, v20, s[40:43], s47 offen sc1
    s_mov_b32 s47, 290816
    buffer_load_dword v19, v20, s[40:43], s47 offen sc1
F_H7:
    s_barrier
    s_mov_b32 s48, 0
    s_cmp_lg_u32 s53, 3
    s_cbranch_scc1 F_H_PZ
F_H_POLL:
    s_waitcnt vmcnt(0)
    v_xor_b32 v16, s55, v16
    v_xor_b32 v17, s55, v17
    v_xor_b32 v18, s55, v18
    v_xor_b32 v19, s55, v19
    v_or3_b32 v16, v16, v17, v18
    v_or_b32 v16, v16, v19
    v_cmp_ne_u32 vcc, 0, v16
    s_add_u32 s48, s48, 1
    s_cbranch_vccz F_H_POLLOK
    s_mov_b32 s47, 278528
    buffer_load_dword v16, v20, s[40:43], s47 offen sc1
    s_mov_b32 s47, 282624
    buffer_load_dword v17, v20, s[40:43], s47 offen sc1
    s_mov_b32 s47, 286720
    buffer_load_dword v18, v20, s[40:43], s47 offen sc1
    s_mov_b32 s47, 290816
    buffer_load_dword v19, v20, s[40:43], s47 offen sc1
    s_cmp_lt_u32 s48, 65536
    s_cbranch_scc1 F_H_POLL
    s_waitcnt vmcnt(0)
F_H_POLLOK:
    ds_write_b32 v9, v8 offset:4
    s_branch F_H_GO
F_H_PZ:
    v_mov_b32 v24, -1
    v_mov_b32 v25, -1
    v_mov_b32 v26, -1
    v_mov_b32 v27, -1
    s_mul_i32 s49, s67, 1280
    s_add_u32 s49, s49, 524288
    s_mul_i32 s50, s53, 39680
    s_add_u32 s50, s50, s62
    s_sub_u32 s50, s50, 40960
    s_cmp_eq_u32 s53, 0
    s_cselect_b32 s49, s49, s50
    buffer_store_dwordx4 v[24:27], v7, s[40:43], s49 offen sc1
    buffer_store_dwordx4 v[24:27], v7, s[40:43], s49 offen offset:1024 sc1
    buffer_store_dwordx4 v[24:27], v7, s[40:43], s49 offen offset:2048 sc1
    buffer_store_dwordx4 v[24:27], v7, s[40:43], s49 offen offset:3072 sc1
    s_add_u32 s49, s49, 4096
    buffer_store_dwordx4 v[24:27], v7, s[40:43], s49 offen sc1
F_H_WAIT:
    s_sleep 4
    ds_read_b32 v1, v9 offset:4
    s_waitcnt lgkmcnt(0)
    v_readfirstlane_b32 s47, v1
    s_add_u32 s48, s48, 1
    s_cmp_ge_u32 s48, 1048576
    s_cbranch_scc1 F_H_GO
    s_cmp_eq_u32 s47, 0
    s_cbranch_scc1 F_H_WAIT
F_H_GO:
    buffer_load_dwordx4 v[32:35], v7, s[40:43], s56 offen sc1
    buffer_load_dwordx4 v[36:39], v7, s[40:43], s56 offen offset:1024 sc1
    buffer_load_dwordx4 v[40:43], v7, s[40:43], s56 offen offset:2048 sc1
    buffer_load_dwordx4 v[44:47], v7, s[40:43], s56 offen offset:3072 sc1
    s_add_u32 s56, s56, 4096
    ds_read_b128 v[16:19], v10
    ds_read_b128 v[20:23], v10 offset:4096
    ds_read_b128 v[24:27], v11
    ds_read_b128 v[28:31], v11 offset:4096
    s_waitcnt vmcnt(2) lgkmcnt(2)
    s_setprio 0
    v_mfma_f32_32x32x16_bf16 v[64:79], v[32:35], v[16:19], 0
    v_mfma_f32_32x32x16_bf16 v[96:111], v[36:39], v[16:19], 0
    v_mfma_f32_32x32x16_bf16 v[80:95], v[32:35], v[20:23], 0
    v_mfma_f32_32x32x16_bf16 v[112:127], v[36:39], v[20:23], 0
    s_setprio 3
    buffer_load_dwordx4 v[32:35], v7, s[40:43], s56 offen sc1
    buffer_load_dwordx4 v[36:39], v7, s[40:43], s56 offen offset:1024 sc1
    s_lshl_b32 s49, s67, 6
    s_add_u32 s49, s49, 393216
    v_mov_b32 v3, s55
    s_mov_b64 exec, 1
    buffer_store_dword v3, v9, s[40:43], s49 offen sc1
    s_mov_b64 exec, -1
    ds_read_b128 v[16:19], v12
    ds_read_b128 v[20:23], v12 offset:4096
    s_waitcnt vmcnt(3) lgkmcnt(2)
    s_setprio 0
    v_mfma_f32_32x32x16_bf16 v[64:79], v[40:43], v[24:27], v[64:79]
    v_mfma_f32_32x32x16_bf16 v[96:111], v[44:47], v[24:27], v[96:111]
    v_mfma_f32_32x32x16_bf16 v[80:95], v[40:43], v[28:31], v[80:95]
    v_mfma_f32_32x32x16_bf16 v[112:127], v[44:47], v[28:31], v[112:127]
    s_setprio 3
    buffer_load_dwordx4 v[40:43], v7, s[40:43], s56 offen offset:2048 sc1
    buffer_load_dwordx4 v[44:47], v7, s[40:43], s56 offen offset:3072 sc1
    s_add_u32 s56, s56, 4096
    s_lshl_b32 s50, s59, 2
    s_add_u32 m0, s58, 61440
    s_nop 0
    buffer_load_dwordx4 v136, s[28:31], s50 offen lds
    ds_read_b128 v[24:27], v13
    ds_read_b128 v[28:31], v13 offset:4096
    s_waitcnt vmcnt(4) lgkmcnt(2)
    s_setprio 0
    v_mfma_f32_32x32x16_bf16 v[64:79], v[32:35], v[16:19], v[64:79]
    v_mfma_f32_32x32x16_bf16 v[96:111], v[36:39], v[16:19], v[96:111]
    v_mfma_f32_32x32x16_bf16 v[80:95], v[32:35], v[20:23], v[80:95]
    v_mfma_f32_32x32x16_bf16 v[112:127], v[36:39], v[20:23], v[112:127]
    s_setprio 3
    buffer_load_dwordx4 v[32:35], v7, s[40:43], s56 offen sc1
    buffer_load_dwordx4 v[36:39], v7, s[40:43], s56 offen offset:1024 sc1
    buffer_load_dword v145, v146, s[28:31], s51 offen
    ds_read_b128 v[16:19], v10 offset:8192
    ds_read_b128 v[20:23], v10 offset:12288
    s_waitcnt vmcnt(4) lgkmcnt(2)
    s_setprio 0
    v_mfma_f32_32x32x16_bf16 v[64:79], v[40:43], v[24:27], v[64:79]
    v_mfma_f32_32x32x16_bf16 v[96:111], v[44:47], v[24:27], v[96:111]
    v_mfma_f32_32x32x16_bf16 v[80:95], v[40:43], v[28:31], v[80:95]
    v_mfma_f32_32x32x16_bf16 v[112:127], v[44:47], v[28:31], v[112:127]
    s_setprio 3
    buffer_load_dwordx4 v[40:43], v7, s[40:43], s56 offen offset:2048 sc1
    buffer_load_dwordx4 v[44:47], v7, s[40:43], s56 offen offset:3072 sc1
    s_add_u32 s56, s56, 4096
    s_add_u32 m0, s58, 61440
    s_nop 0
    buffer_load_dwordx4 v137, s[28:31], s50 offen offset:1024 lds
    ds_read_b128 v[24:27], v11 offset:8192
    ds_read_b128 v[28:31], v11 offset:12288
    s_waitcnt vmcnt(4) lgkmcnt(2)
    s_setprio 0
    v_mfma_f32_32x32x16_bf16 v[64:79], v[32:35], v[16:19], v[64:79]
    v_mfma_f32_32x32x16_bf16 v[96:111], v[36:39], v[16:19], v[96:111]
    v_mfma_f32_32x32x16_bf16 v[80:95], v[32:35], v[20:23], v[80:95]
    v_mfma_f32_32x32x16_bf16 v[112:127], v[36:39], v[20:23], v[112:127]
    s_setprio 3
    buffer_load_dwordx4 v[32:35], v7, s[40:43], s56 offen sc1
    buffer_load_dwordx4 v[36:39], v7, s[40:43], s56 offen offset:1024 sc1
    ds_read_b128 v[16:19], v12 offset:8192
    ds_read_b128 v[20:23], v12 offset:12288
    s_waitcnt vmcnt(3) lgkmcnt(2)
    s_setprio 0
    v_mfma_f32_32x32x16_bf16 v[64:79], v[40:43], v[24:27], v[64:79]
    v_mfma_f32_32x32x16_bf16 v[96:111], v[44:47], v[24:27], v[96:111]
    v_mfma_f32_32x32x16_bf16 v[80:95], v[40:43], v[28:31], v[80:95]
    v_mfma_f32_32x32x16_bf16 v[112:127], v[44:47], v[28:31], v[112:127]
    s_setprio 3
    buffer_load_dwordx4 v[40:43], v7, s[40:43], s56 offen offset:2048 sc1
    buffer_load_dwordx4 v[44:47], v7, s[40:43], s56 offen offset:3072 sc1
    s_add_u32 s56, s56, 4096
    s_add_u32 m0, s58, 61440
    s_nop 0
    buffer_load_dwordx4 v138, s[28:31], s50 offen offset:2048 lds
    ds_read_b128 v[24:27], v13 offset:8192
    ds_read_b128 v[28:31], v13 offset:12288
    s_waitcnt vmcnt(3) lgkmcnt(2)
    s_setprio 0
    v_mfma_f32_32x32x16_bf16 v[64:79], v[32:35], v[16:19], v[64:79]
    v_mfma_f32_32x32x16_bf16 v[96:111], v[36:39], v[16:19], v[96:111]
    v_mfma_f32_32x32x16_bf16 v[80:95], v[32:35], v[20:23], v[80:95]
    v_mfma_f32_32x32x16_bf16 v[112:127], v[36:39], v[20:23], v[112:127]
    s_setprio 3
    buffer_load_dwordx4 v[32:35], v7, s[40:43], s56 offen sc1
    buffer_load_dwordx4 v[36:39], v7, s[40:43], s56 offen offset:1024 sc1
    ds_read_b128 v[16:19], v10 offset:16384
    ds_read_b128 v[20:23], v10 offset:20480
    s_waitcnt vmcnt(3) lgkmcnt(2)
    s_setprio 0
    v_mfma_f32_32x32x16_bf16 v[64:79], v[40:43], v[24:27], v[64:79]
    v_mfma_f32_32x32x16_bf16 v[96:111], v[44:47], v[24:27], v[96:111]
    v_mfma_f32_32x32x16_bf16 v[80:95], v[40:43], v[28:31], v[80:95]
    v_mfma_f32_32x32x16_bf16 v[112:127], v[44:47], v[28:31], v[112:127]
    s_setprio 3
    buffer_load_dwordx4 v[40:43], v7, s[40:43], s56 offen offset:2048 sc1
    buffer_load_dwordx4 v[44:47], v7, s[40:43], s56 offen offset:3072 sc1
    s_add_u32 s56, s56, 4096
    s_add_u32 m0, s58, 61440
    s_nop 0
    buffer_load_dwordx4 v139, s[28:31], s50 offen offset:3072 lds
    ds_read_b128 v[24:27], v11 offset:16384
    ds_read_b128 v[28:31], v11 offset:20480
    s_waitcnt vmcnt(3) lgkmcnt(2)
    s_setprio 0
    v_mfma_f32_32x32x16_bf16 v[64:79], v[32:35], v[16:19], v[64:79]
    v_mfma_f32_32x32x16_bf16 v[96:111], v[36:39], v[16:19], v[96:111]
    v_mfma_f32_32x32x16_bf16 v[80:95], v[32:35], v[20:23], v[80:95]
    v_mfma_f32_32x32x16_bf16 v[112:127], v[36:39], v[20:23], v[112:127]
    s_setprio 3
    buffer_load_dwordx4 v[32:35], v7, s[40:43], s56 offen sc1
    buffer_load_dwordx4 v[36:39], v7, s[40:43], s56 offen offset:1024 sc1
    ds_read_b128 v[16:19], v12 offset:16384
    ds_read_b128 v[20:23], v12 offset:20480
    s_waitcnt vmcnt(3) lgkmcnt(2)
    s_setprio 0
    v_mfma_f32_32x32x16_bf16 v[64:79], v[40:43], v[24:27], v[64:79]
    v_mfma_f32_32x32x16_bf16 v[96:111], v[44:47], v[24:27], v[96:111]
    v_mfma_f32_32x32x16_bf16 v[80:95], v[40:43], v[28:31], v[80:95]
    v_mfma_f32_32x32x16_bf16 v[112:127], v[44:47], v[28:31], v[112:127]
    s_setprio 3
    buffer_load_dwordx4 v[40:43], v7, s[40:43], s56 offen offset:2048 sc1
    buffer_load_dwordx4 v[44:47], v7, s[40:43], s56 offen offset:3072 sc1
    s_add_u32 s56, s56, 4096
    s_add_u32 m0, s58, 65536
    s_nop 0
    buffer_load_dwordx4 v140, s[28:31], s50 offen lds
    ds_read_b128 v[24:27], v13 offset:16384
    ds_read_b128 v[28:31], v13 offset:20480
    s_waitcnt vmcnt(3) lgkmcnt(2)
    s_setprio 0
    v_mfma_f32_32x32x16_bf16 v[64:79], v[32:35], v[16:19], v[64:79]
    v_mfma_f32_32x32x16_bf16 v[96:111], v[36:39], v[16:19], v[96:111]
    v_mfma_f32_32x32x16_bf16 v[80:95], v[32:35], v[20:23], v[80:95]
    v_mfma_f32_32x32x16_bf16 v[112:127], v[36:39], v[20:23], v[112:127]
    s_setprio 3
    buffer_load_dwordx4 v[32:35], v7, s[40:43], s56 offen sc1
    buffer_load_dwordx4 v[36:39], v7, s[40:43], s56 offen offset:1024 sc1
    buffer_load_dword v145, v146, s[32:35], s51 offen
    s_add_u32 s51, s51, 491520
    ds_read_b128 v[16:19], v10 offset:24576
    ds_read_b128 v[20:23], v10 offset:28672
    s_waitcnt vmcnt(4) lgkmcnt(2)
    s_setprio 0
    v_mfma_f32_32x32x16_bf16 v[64:79], v[40:43], v[24:27], v[64:79]
    v_mfma_f32_32x32x16_bf16 v[96:111], v[44:47], v[24:27], v[96:111]
    v_mfma_f32_32x32x16_bf16 v[80:95], v[40:43], v[28:31], v[80:95]
    v_mfma_f32_32x32x16_bf16 v[112:127], v[44:47], v[28:31], v[112:127]
    s_setprio 3
    buffer_load_dwordx4 v[40:43], v7, s[40:43], s56 offen offset:2048 sc1
    buffer_load_dwordx4 v[44:47], v7, s[40:43], s56 offen offset:3072 sc1
    s_add_u32 s56, s56, 4096
    s_add_u32 s50, s59, 614400
    s_add_u32 m0, s58, 40960
    s_nop 0
    buffer_load_dwordx4 v128, s[28:31], s50 offen lds
    ds_read_b128 v[24:27], v11 offset:24576
    ds_read_b128 v[28:31], v11 offset:28672
    s_waitcnt vmcnt(4) lgkmcnt(2)
    s_setprio 0
    v_mfma_f32_32x32x16_bf16 v[64:79], v[32:35], v[16:19], v[64:79]
    v_mfma_f32_32x32x16_bf16 v[96:111], v[36:39], v[16:19], v[96:111]
    v_mfma_f32_32x32x16_bf16 v[80:95], v[32:35], v[20:23], v[80:95]
    v_mfma_f32_32x32x16_bf16 v[112:127], v[36:39], v[20:23], v[112:127]
    s_setprio 3
    buffer_load_dwordx4 v[32:35], v7, s[40:43], s56 offen sc1
    buffer_load_dwordx4 v[36:39], v7, s[40:43], s56 offen offset:1024 sc1
    ds_read_b128 v[16:19], v12 offset:24576
    ds_read_b128 v[20:23], v12 offset:28672
    s_waitcnt vmcnt(3) lgkmcnt(2)
    s_setprio 0
    v_mfma_f32_32x32x16_bf16 v[64:79], v[40:43], v[24:27], v[64:79]
    v_mfma_f32_32x32x16_bf16 v[96:111], v[44:47], v[24:27], v[96:111]
    v_mfma_f32_32x32x16_bf16 v[80:95], v[40:43], v[28:31], v[80:95]
    v_mfma_f32_32x32x16_bf16 v[112:127], v[44:47], v[28:31], v[112:127]
    s_setprio 3
    buffer_load_dwordx4 v[40:43], v7, s[40:43], s56 offen offset:2048 sc1
    buffer_load_dwordx4 v[44:47], v7, s[40:43], s56 offen offset:3072 sc1
    s_add_u32 s56, s56, 4096
    s_add_u32 m0, s58, 40960
    s_nop 0
    buffer_load_dwordx4 v129, s[28:31], s50 offen offset:1024 lds
    ds_read_b128 v[24:27], v13 offset:24576
    ds_read_b128 v[28:31], v13 offset:28672
    s_waitcnt vmcnt(3) lgkmcnt(2)
    s_setprio 0
    v_mfma_f32_32x32x16_bf16 v[64:79], v[32:35], v[16:19], v[64:79]
    v_mfma_f32_32x32x16_bf16 v[96:111], v[36:39], v[16:19], v[96:111]
    v_mfma_f32_32x32x16_bf16 v[80:95], v[32:35], v[20:23], v[80:95]
    v_mfma_f32_32x32x16_bf16 v[112:127], v[36:39], v[20:23], v[112:127]
    s_setprio 3
    buffer_load_dwordx4 v[32:35], v7, s[40:43], s56 offen sc1
    buffer_load_dwordx4 v[36:39], v7, s[40:43], s56 offen offset:1024 sc1
    ds_read_b128 v[16:19], v10 offset:32768
    ds_read_b128 v[20:23], v10 offset:36864
    s_waitcnt vmcnt(3) lgkmcnt(2)
    s_setprio 0
    v_mfma_f32_32x32x16_bf16 v[64:79], v[40:43], v[24:27], v[64:79]
    v_mfma_f32_32x32x16_bf16 v[96:111], v[44:47], v[24:27], v[96:111]
    v_mfma_f32_32x32x16_bf16 v[80:95], v[40:43], v[28:31], v[80:95]
    v_mfma_f32_32x32x16_bf16 v[112:127], v[44:47], v[28:31], v[112:127]
    s_setprio 3
    buffer_load_dwordx4 v[40:43], v7, s[40:43], s56 offen offset:2048 sc1
    buffer_load_dwordx4 v[44:47], v7, s[40:43], s56 offen offset:3072 sc1
    s_add_u32 s56, s56, 4096
    s_add_u32 m0, s58, 40960
    s_nop 0
    buffer_load_dwordx4 v130, s[28:31], s50 offen offset:2048 lds
    ds_read_b128 v[24:27], v11 offset:32768
    ds_read_b128 v[28:31], v11 offset:36864
    s_waitcnt vmcnt(3) lgkmcnt(2)
    s_setprio 0
    v_mfma_f32_32x32x16_bf16 v[64:79], v[32:35], v[16:19], v[64:79]
    v_mfma_f32_32x32x16_bf16 v[96:111], v[36:39], v[16:19], v[96:111]
    v_mfma_f32_32x32x16_bf16 v[80:95], v[32:35], v[20:23], v[80:95]
    v_mfma_f32_32x32x16_bf16 v[112:127], v[36:39], v[20:23], v[112:127]
    s_setprio 3
    buffer_load_dwordx4 v[32:35], v7, s[40:43], s56 offen sc1
    buffer_load_dwordx4 v[36:39], v7, s[40:43], s56 offen offset:1024 sc1
    ds_read_b128 v[16:19], v12 offset:32768
    ds_read_b128 v[20:23], v12 offset:36864
    s_waitcnt vmcnt(3) lgkmcnt(2)
    s_setprio 0
    v_mfma_f32_32x32x16_bf16 v[64:79], v[40:43], v[24:27], v[64:79]
    v_mfma_f32_32x32x16_bf16 v[96:111], v[44:47], v[24:27], v[96:111]
    v_mfma_f32_32x32x16_bf16 v[80:95], v[40:43], v[28:31], v[80:95]
    v_mfma_f32_32x32x16_bf16 v[112:127], v[44:47], v[28:31], v[112:127]
    s_setprio 3
    buffer_load_dwordx4 v[40:43], v7, s[40:43], s56 offen offset:2048 sc1
    buffer_load_dwordx4 v[44:47], v7, s[40:43], s56 offen offset:3072 sc1
    s_add_u32 s56, s56, 4096
    s_add_u32 m0, s58, 40960
    s_nop 0
    buffer_load_dwordx4 v131, s[28:31], s50 offen offset:3072 lds
    ds_read_b128 v[24:27], v13 offset:32768
    ds_read_b128 v[28:31], v13 offset:36864
    s_waitcnt vmcnt(3) lgkmcnt(2)
    s_setprio 0
    v_mfma_f32_32x32x16_bf16 v[64:79], v[32:35], v[16:19], v[64:79]
    v_mfma_f32_32x32x16_bf16 v[96:111], v[36:39], v[16:19], v[96:111]
    v_mfma_f32_32x32x16_bf16 v[80:95], v[32:35], v[20:23], v[80:95]
    v_mfma_f32_32x32x16_bf16 v[112:127], v[36:39], v[20:23], v[112:127]
    s_setprio 3
    buffer_load_dwordx4 v[32:35], v7, s[40:43], s56 offen sc1
    buffer_load_dwordx4 v[36:39], v7, s[40:43], s56 offen offset:1024 sc1
    buffer_load_dword v145, v146, s[28:31], s51 offen
    ds_read_b128 v[16:19], v10 offset:40960
    ds_read_b128 v[20:23], v10 offset:45056
    s_waitcnt vmcnt(4) lgkmcnt(2)
    s_setprio 0
    v_mfma_f32_32x32x16_bf16 v[64:79], v[40:43], v[24:27], v[64:79]
    v_mfma_f32_32x32x16_bf16 v[96:111], v[44:47], v[24:27], v[96:111]
    v_mfma_f32_32x32x16_bf16 v[80:95], v[40:43], v[28:31], v[80:95]
    v_mfma_f32_32x32x16_bf16 v[112:127], v[44:47], v[28:31], v[112:127]
    s_setprio 3
    buffer_load_dwordx4 v[40:43], v7, s[40:43], s56 offen offset:2048 sc1
    buffer_load_dwordx4 v[44:47], v7, s[40:43], s56 offen offset:3072 sc1
    s_add_u32 s56, s56, 4096
    s_add_u32 m0, s58, 45056
    s_nop 0
    buffer_load_dwordx4 v132, s[28:31], s50 offen lds
    ds_read_b128 v[24:27], v11 offset:40960
    ds_read_b128 v[28:31], v11 offset:45056
    s_waitcnt vmcnt(4) lgkmcnt(2)
    s_setprio 0
    v_mfma_f32_32x32x16_bf16 v[64:79], v[32:35], v[16:19], v[64:79]
    v_mfma_f32_32x32x16_bf16 v[96:111], v[36:39], v[16:19], v[96:111]
    v_mfma_f32_32x32x16_bf16 v[80:95], v[32:35], v[20:23], v[80:95]
    v_mfma_f32_32x32x16_bf16 v[112:127], v[36:39], v[20:23], v[112:127]
    s_setprio 3
    buffer_load_dwordx4 v[32:35], v7, s[40:43], s56 offen sc1
    buffer_load_dwordx4 v[36:39], v7, s[40:43], s56 offen offset:1024 sc1
    ds_read_b128 v[16:19], v12 offset:40960
    ds_read_b128 v[20:23], v12 offset:45056
    s_waitcnt vmcnt(3) lgkmcnt(2)
    s_setprio 0
    v_mfma_f32_32x32x16_bf16 v[64:79], v[40:43], v[24:27], v[64:79]
    v_mfma_f32_32x32x16_bf16 v[96:111], v[44:47], v[24:27], v[96:111]
    v_mfma_f32_32x32x16_bf16 v[80:95], v[40:43], v[28:31], v[80:95]
    v_mfma_f32_32x32x16_bf16 v[112:127], v[44:47], v[28:31], v[112:127]
    s_setprio 3
    buffer_load_dwordx4 v[40:43], v7, s[40:43], s56 offen offset:2048 sc1
    buffer_load_dwordx4 v[44:47], v7, s[40:43], s56 offen offset:3072 sc1
    s_add_u32 s56, s56, 4096
    s_add_u32 s50, s59, 409600
    s_add_u32 m0, s58, 20480
    s_nop 0
    buffer_load_dwordx4 v128, s[28:31], s50 offen lds
    ds_read_b128 v[24:27], v13 offset:40960
    ds_read_b128 v[28:31], v13 offset:45056
    s_waitcnt vmcnt(3) lgkmcnt(2)
    s_setprio 0
    v_mfma_f32_32x32x16_bf16 v[64:79], v[32:35], v[16:19], v[64:79]
    v_mfma_f32_32x32x16_bf16 v[96:111], v[36:39], v[16:19], v[96:111]
    v_mfma_f32_32x32x16_bf16 v[80:95], v[32:35], v[20:23], v[80:95]
    v_mfma_f32_32x32x16_bf16 v[112:127], v[36:39], v[20:23], v[112:127]
    s_setprio 3
    buffer_load_dwordx4 v[32:35], v7, s[40:43], s56 offen sc1
    buffer_load_dwordx4 v[36:39], v7, s[40:43], s56 offen offset:1024 sc1
    ds_read_b128 v[16:19], v10 offset:49152
    ds_read_b128 v[20:23], v10 offset:53248
    s_waitcnt vmcnt(3) lgkmcnt(2)
    s_setprio 0
    v_mfma_f32_32x32x16_bf16 v[64:79], v[40:43], v[24:27], v[64:79]
    v_mfma_f32_32x32x16_bf16 v[96:111], v[44:47], v[24:27], v[96:111]
    v_mfma_f32_32x32x16_bf16 v[80:95], v[40:43], v[28:31], v[80:95]
    v_mfma_f32_32x32x16_bf16 v[112:127], v[44:47], v[28:31], v[112:127]
    s_setprio 3
    buffer_load_dwordx4 v[40:43], v7, s[40:43], s56 offen offset:2048 sc1
    buffer_load_dwordx4 v[44:47], v7, s[40:43], s56 offen offset:3072 sc1
    s_add_u32 s56, s56, 4096
    s_add_u32 m0, s58, 20480
    s_nop 0
    buffer_load_dwordx4 v129, s[28:31], s50 offen offset:1024 lds
    ds_read_b128 v[24:27], v11 offset:49152
    ds_read_b128 v[28:31], v11 offset:53248
    s_waitcnt vmcnt(3) lgkmcnt(2)
    s_setprio 0
    v_mfma_f32_32x32x16_bf16 v[64:79], v[32:35], v[16:19], v[64:79]
    v_mfma_f32_32x32x16_bf16 v[96:111], v[36:39], v[16:19], v[96:111]
    v_mfma_f32_32x32x16_bf16 v[80:95], v[32:35], v[20:23], v[80:95]
    v_mfma_f32_32x32x16_bf16 v[112:127], v[36:39], v[20:23], v[112:127]
    s_setprio 3
    buffer_load_dwordx4 v[32:35], v7, s[40:43], s56 offen sc1
    buffer_load_dwordx4 v[36:39], v7, s[40:43], s56 offen offset:1024 sc1
    ds_read_b128 v[16:19], v12 offset:49152
    ds_read_b128 v[20:23], v12 offset:53248
    s_waitcnt vmcnt(3) lgkmcnt(2)
    s_setprio 0
    v_mfma_f32_32x32x16_bf16 v[64:79], v[40:43], v[24:27], v[64:79]
    v_mfma_f32_32x32x16_bf16 v[96:111], v[44:47], v[24:27], v[96:111]
    v_mfma_f32_32x32x16_bf16 v[80:95], v[40:43], v[28:31], v[80:95]
    v_mfma_f32_32x32x16_bf16 v[112:127], v[44:47], v[28:31], v[112:127]
    s_setprio 3
    buffer_load_dwordx4 v[40:43], v7, s[40:43], s56 offen offset:2048 sc1
    buffer_load_dwordx4 v[44:47], v7, s[40:43], s56 offen offset:3072 sc1
    s_add_u32 s56, s56, 4096
    s_add_u32 m0, s58, 20480
    s_nop 0
    buffer_load_dwordx4 v130, s[28:31], s50 offen offset:2048 lds
    ds_read_b128 v[24:27], v13 offset:49152
    ds_read_b128 v[28:31], v13 offset:53248
    s_waitcnt vmcnt(3) lgkmcnt(2)
    s_setprio 0
    v_mfma_f32_32x32x16_bf16 v[64:79], v[32:35], v[16:19], v[64:79]
    v_mfma_f32_32x32x16_bf16 v[96:111], v[36:39], v[16:19], v[96:111]
    v_mfma_f32_32x32x16_bf16 v[80:95], v[32:35], v[20:23], v[80:95]
    v_mfma_f32_32x32x16_bf16 v[112:127], v[36:39], v[20:23], v[112:127]
    s_setprio 3
    buffer_load_dwordx4 v[32:35], v7, s[40:43], s56 offen sc1
    buffer_load_dwordx4 v[36:39], v7, s[40:43], s56 offen offset:1024 sc1
    buffer_load_dword v145, v146, s[32:35], s51 offen
    s_add_u32 s51, s51, 491520
    ds_read_b128 v[16:19], v10 offset:57344
    ds_read_b128 v[20:23], v10 offset:61440
    s_waitcnt vmcnt(4) lgkmcnt(2)
    s_setprio 0
    v_mfma_f32_32x32x16_bf16 v[64:79], v[40:43], v[24:27], v[64:79]
    v_mfma_f32_32x32x16_bf16 v[96:111], v[44:47], v[24:27], v[96:111]
    v_mfma_f32_32x32x16_bf16 v[80:95], v[40:43], v[28:31], v[80:95]
    v_mfma_f32_32x32x16_bf16 v[112:127], v[44:47], v[28:31], v[112:127]
    s_setprio 3
    buffer_load_dwordx4 v[40:43], v7, s[40:43], s56 offen offset:2048 sc1
    buffer_load_dwordx4 v[44:47], v7, s[40:43], s56 offen offset:3072 sc1
    s_add_u32 s56, s56, 4096
    s_add_u32 m0, s58, 20480
    s_nop 0
    buffer_load_dwordx4 v131, s[28:31], s50 offen offset:3072 lds
    ds_read_b128 v[24:27], v11 offset:57344
    ds_read_b128 v[28:31], v11 offset:61440
    s_waitcnt vmcnt(4) lgkmcnt(2)
    s_setprio 0
    v_mfma_f32_32x32x16_bf16 v[64:79], v[32:35], v[16:19], v[64:79]
    v_mfma_f32_32x32x16_bf16 v[96:111], v[36:39], v[16:19], v[96:111]
    v_mfma_f32_32x32x16_bf16 v[80:95], v[32:35], v[20:23], v[80:95]
    v_mfma_f32_32x32x16_bf16 v[112:127], v[36:39], v[20:23], v[112:127]
    s_setprio 3
    buffer_load_dwordx4 v[32:35], v7, s[40:43], s56 offen sc1
    buffer_load_dwordx4 v[36:39], v7, s[40:43], s56 offen offset:1024 sc1
    ds_read_b128 v[16:19], v12 offset:57344
    ds_read_b128 v[20:23], v12 offset:61440
    s_waitcnt vmcnt(3) lgkmcnt(2)
    s_setprio 0
    v_mfma_f32_32x32x16_bf16 v[64:79], v[40:43], v[24:27], v[64:79]
    v_mfma_f32_32x32x16_bf16 v[96:111], v[44:47], v[24:27], v[96:111]
    v_mfma_f32_32x32x16_bf16 v[80:95], v[40:43], v[28:31], v[80:95]
    v_mfma_f32_32x32x16_bf16 v[112:127], v[44:47], v[28:31], v[112:127]
    s_setprio 3
    buffer_load_dwordx4 v[40:43], v7, s[40:43], s56 offen offset:2048 sc1
    buffer_load_dwordx4 v[44:47], v7, s[40:43], s56 offen offset:3072 sc1
    s_add_u32 s56, s56, 4096
    s_add_u32 m0, s58, 24576
    s_nop 0
    buffer_load_dwordx4 v132, s[28:31], s50 offen lds
    ds_read_b128 v[24:27], v13 offset:57344
    ds_read_b128 v[28:31], v13 offset:61440
    s_waitcnt vmcnt(3) lgkmcnt(2)
    s_setprio 0
    v_mfma_f32_32x32x16_bf16 v[64:79], v[32:35], v[16:19], v[64:79]
    v_mfma_f32_32x32x16_bf16 v[96:111], v[36:39], v[16:19], v[96:111]
    v_mfma_f32_32x32x16_bf16 v[80:95], v[32:35], v[20:23], v[80:95]
    v_mfma_f32_32x32x16_bf16 v[112:127], v[36:39], v[20:23], v[112:127]
    s_setprio 3
    buffer_load_dwordx4 v[32:35], v7, s[40:43], s56 offen sc1
    buffer_load_dwordx4 v[36:39], v7, s[40:43], s56 offen offset:1024 sc1
    v_add_u32 v10, 0x10000, v10
    v_add_u32 v11, 0x10000, v11
    v_add_u32 v12, 0x10000, v12
    v_add_u32 v13, 0x10000, v13
    ds_read_b128 v[16:19], v10
    ds_read_b128 v[20:23], v10 offset:4096
    s_waitcnt vmcnt(3) lgkmcnt(2)
    s_setprio 0
    v_mfma_f32_32x32x16_bf16 v[64:79], v[40:43], v[24:27], v[64:79]
    v_mfma_f32_32x32x16_bf16 v[96:111], v[44:47], v[24:27], v[96:111]
    v_mfma_f32_32x32x16_bf16 v[80:95], v[40:43], v[28:31], v[80:95]
    v_mfma_f32_32x32x16_bf16 v[112:127], v[44:47], v[28:31], v[112:127]
    s_setprio 3
    buffer_load_dwordx4 v[40:43], v7, s[40:43], s56 offen offset:2048 sc1
    buffer_load_dwordx4 v[44:47], v7, s[40:43], s56 offen offset:3072 sc1
    s_add_u32 s56, s56, 4096
    s_add_u32 s50, s59, 0
    s_add_u32 m0, s58, 0
    s_nop 0
    buffer_load_dwordx4 v129, s[32:35], s50 offen offset:1024 lds
    ds_read_b128 v[24:27], v11
    ds_read_b128 v[28:31], v11 offset:4096
    s_waitcnt vmcnt(3) lgkmcnt(2)
    s_setprio 0
    v_mfma_f32_32x32x16_bf16 v[64:79], v[32:35], v[16:19], v[64:79]
    v_mfma_f32_32x32x16_bf16 v[96:111], v[36:39], v[16:19], v[96:111]
    v_mfma_f32_32x32x16_bf16 v[80:95], v[32:35], v[20:23], v[80:95]
    v_mfma_f32_32x32x16_bf16 v[112:127], v[36:39], v[20:23], v[112:127]
    s_setprio 3
    buffer_load_dwordx4 v[32:35], v7, s[40:43], s56 offen sc1
    buffer_load_dwordx4 v[36:39], v7, s[40:43], s56 offen offset:1024 sc1
    ds_read_b128 v[16:19], v12
    ds_read_b128 v[20:23], v12 offset:4096
    s_waitcnt vmcnt(3) lgkmcnt(2)
    s_setprio 0
    v_mfma_f32_32x32x16_bf16 v[64:79], v[40:43], v[24:27], v[64:79]
    v_mfma_f32_32x32x16_bf16 v[96:111], v[44:47], v[24:27], v[96:111]
    v_mfma_f32_32x32x16_bf16 v[80:95], v[40:43], v[28:31], v[80:95]
    v_mfma_f32_32x32x16_bf16 v[112:127], v[44:47], v[28:31], v[112:127]
    s_setprio 3
    buffer_load_dwordx4 v[40:43], v7, s[40:43], s56 offen offset:2048 sc1
    buffer_load_dwordx4 v[44:47], v7, s[40:43], s56 offen offset:3072 sc1
    s_add_u32 s56, s56, 4096
    s_add_u32 m0, s58, 0
    s_nop 0
    buffer_load_dwordx4 v130, s[32:35], s50 offen offset:2048 lds
    ds_read_b128 v[24:27], v13
    ds_read_b128 v[28:31], v13 offset:4096
    s_waitcnt vmcnt(3) lgkmcnt(2)
    s_setprio 0
    v_mfma_f32_32x32x16_bf16 v[64:79], v[32:35], v[16:19], v[64:79]
    v_mfma_f32_32x32x16_bf16 v[96:111], v[36:39], v[16:19], v[96:111]
    v_mfma_f32_32x32x16_bf16 v[80:95], v[32:35], v[20:23], v[80:95]
    v_mfma_f32_32x32x16_bf16 v[112:127], v[36:39], v[20:23], v[112:127]
    s_setprio 3
    buffer_load_dwordx4 v[32:35], v7, s[40:43], s56 offen sc1
    buffer_load_dwordx4 v[36:39], v7, s[40:43], s56 offen offset:1024 sc1
    s_lshl_b32 s49, s46, 8
    s_cmp_eq_u32 s45, 0
    s_cselect_b32 s47, 2048, 0
    s_add_u32 s49, s49, s47
    v_lshlrev_b32 v147, 6, v0
    v_add_u32 v147, 2048, v147
    s_mov_b32 exec_lo, 0
    v_and_b32 v147, 0xc0, v147
    v_add_u32 v147, s49, v147
    s_mov_b32 exec_lo, -1
    s_lshl_b32 s49, s45, 11
    s_add_u32 s49, s49, 391168
    buffer_load_dword v147, v147, s[40:43], s49 offen sc1
    ds_read_b128 v[16:19], v10 offset:8192
    ds_read_b128 v[20:23], v10 offset:12288
    s_waitcnt vmcnt(4) lgkmcnt(2)
    s_setprio 0
    v_mfma_f32_32x32x16_bf16 v[64:79], v[40:43], v[24:27], v[64:79]
    v_mfma_f32_32x32x16_bf16 v[96:111], v[44:47], v[24:27], v[96:111]
    v_mfma_f32_32x32x16_bf16 v[80:95], v[40:43], v[28:31], v[80:95]
    v_mfma_f32_32x32x16_bf16 v[112:127], v[44:47], v[28:31], v[112:127]
    s_setprio 3
    buffer_load_dwordx4 v[40:43], v7, s[40:43], s56 offen offset:2048 sc1
    buffer_load_dwordx4 v[44:47], v7, s[40:43], s56 offen offset:3072 sc1
    s_add_u32 s56, s56, 4096
    s_add_u32 m0, s58, 0
    s_nop 0
    buffer_load_dwordx4 v131, s[32:35], s50 offen offset:3072 lds
    ds_read_b128 v[24:27], v11 offset:8192
    ds_read_b128 v[28:31], v11 offset:12288
    s_waitcnt vmcnt(4) lgkmcnt(2)
    s_setprio 0
    v_mfma_f32_32x32x16_bf16 v[64:79], v[32:35], v[16:19], v[64:79]
    v_mfma_f32_32x32x16_bf16 v[96:111], v[36:39], v[16:19], v[96:111]
    v_mfma_f32_32x32x16_bf16 v[80:95], v[32:35], v[20:23], v[80:95]
    v_mfma_f32_32x32x16_bf16 v[112:127], v[36:39], v[20:23], v[112:127]
    s_setprio 3
    buffer_load_dwordx4 v[32:35], v7, s[40:43], s56 offen sc1
    buffer_load_dwordx4 v[36:39], v7, s[40:43], s56 offen offset:1024 sc1
    ds_read_b128 v[16:19], v12 offset:8192
    ds_read_b128 v[20:23], v12 offset:12288
    s_waitcnt vmcnt(3) lgkmcnt(2)
    s_setprio 0
    v_mfma_f32_32x32x16_bf16 v[64:79], v[40:43], v[24:27], v[64:79]
    v_mfma_f32_32x32x16_bf16 v[96:111], v[44:47], v[24:27], v[96:111]
    v_mfma_f32_32x32x16_bf16 v[80:95], v[40:43], v[28:31], v[80:95]
    v_mfma_f32_32x32x16_bf16 v[112:127], v[44:47], v[28:31], v[112:127]
    s_setprio 3
    buffer_load_dwordx4 v[40:43], v7, s[40:43], s56 offen offset:2048 sc1
    buffer_load_dwordx4 v[44:47], v7, s[40:43], s56 offen offset:3072 sc1
    s_add_u32 s56, s56, 4096
    s_add_u32 m0, s58, 4096
    s_nop 0
    buffer_load_dwordx4 v132, s[32:35], s50 offen lds
    ds_read_b128 v[24:27], v13 offset:8192
    ds_read_b128 v[28:31], v13 offset:12288
    s_waitcnt vmcnt(3) lgkmcnt(2)
    s_setprio 0
    v_mfma_f32_32x32x16_bf16 v[64:79], v[32:35], v[16:19], v[64:79]
    v_mfma_f32_32x32x16_bf16 v[96:111], v[36:39], v[16:19], v[96:111]
    v_mfma_f32_32x32x16_bf16 v[80:95], v[32:35], v[20:23], v[80:95]
    v_mfma_f32_32x32x16_bf16 v[112:127], v[36:39], v[20:23], v[112:127]
    s_setprio 3
    s_waitcnt vmcnt(1) lgkmcnt(0)
    s_setprio 0
    v_mfma_f32_32x32x16_bf16 v[64:79], v[40:43], v[24:27], v[64:79]
    v_mfma_f32_32x32x16_bf16 v[96:111], v[44:47], v[24:27], v[96:111]
    v_mfma_f32_32x32x16_bf16 v[80:95], v[40:43], v[28:31], v[80:95]
    v_mfma_f32_32x32x16_bf16 v[112:127], v[44:47], v[28:31], v[112:127]
    s_setprio 3
    s_waitcnt lgkmcnt(0)
    s_mov_b64 exec, 1
    ds_add_u32 v9, v8 offset:8
    s_mov_b64 exec, -1
    s_add_u32 s57, s57, 4
    s_nop 7
    s_nop 7
    v_mul_f32 v14, 0xbfb8aa3b, v108
    v_mul_f32 v15, 0xbfb8aa3b, v124
    v_cvt_pk_bf16_f32 v64, v64, v65
    v_cvt_pk_bf16_f32 v65, v66, v67
    v_cvt_pk_bf16_f32 v66, v68, v69
    v_cvt_pk_bf16_f32 v67, v70, v71
    v_cvt_pk_bf16_f32 v68, v72, v73
    v_cvt_pk_bf16_f32 v69, v74, v75
    v_cvt_pk_bf16_f32 v70, v76, v77
    v_cvt_pk_bf16_f32 v71, v78, v79
    v_cvt_pk_bf16_f32 v72, v80, v81
    v_cvt_pk_bf16_f32 v73, v82, v83
    v_cvt_pk_bf16_f32 v74, v84, v85
    v_cvt_pk_bf16_f32 v75, v86, v87
    v_cvt_pk_bf16_f32 v76, v88, v89
    v_cvt_pk_bf16_f32 v77, v90, v91
    v_cvt_pk_bf16_f32 v78, v92, v93
    v_cvt_pk_bf16_f32 v79, v94, v95
    v_cvt_pk_bf16_f32 v80, v96, v97
    v_cvt_pk_bf16_f32 v81, v98, v99
    v_cvt_pk_bf16_f32 v82, v100, v101
    v_cvt_pk_bf16_f32 v83, v102, v103
    v_cvt_pk_bf16_f32 v84, v104, v105
    v_cvt_pk_bf16_f32 v85, v106, v107
    v_cvt_pk_bf16_f32 v86, v108, v109
    v_cvt_pk_bf16_f32 v87, v110, v111
    v_cvt_pk_bf16_f32 v88, v112, v113
    v_cvt_pk_bf16_f32 v89, v114, v115
    v_cvt_pk_bf16_f32 v90, v116, v117
    v_cvt_pk_bf16_f32 v91, v118, v119
    v_cvt_pk_bf16_f32 v92, v120, v121
    v_cvt_pk_bf16_f32 v93, v122, v123
    v_cvt_pk_bf16_f32 v94, v124, v125
    v_cvt_pk_bf16_f32 v95, v126, v127
    s_mov_b32 s48, 0
    s_waitcnt vmcnt(8)
F_H_FL:
    v_cmp_ne_u32 vcc, s55, v147
    s_add_u32 s48, s48, 1
    s_cbranch_vccz F_H_FLOK
    s_cmp_ge_u32 s48, 65536
    s_cbranch_scc1 F_H_FLOK
    s_sleep 8
    s_lshl_b32 s49, s46, 8
    s_cmp_eq_u32 s45, 0
    s_cselect_b32 s47, 2048, 0
    s_add_u32 s49, s49, s47
    v_lshlrev_b32 v147, 6, v0
    v_add_u32 v147, 2048, v147
    s_mov_b32 exec_lo, 0
    v_and_b32 v147, 0xc0, v147
    v_add_u32 v147, s49, v147
    s_mov_b32 exec_lo, -1
    s_lshl_b32 s49, s45, 11
    s_add_u32 s49, s49, 391168
    buffer_load_dword v147, v147, s[40:43], s49 offen sc1
    s_waitcnt vmcnt(0)
    s_branch F_H_FL
F_H_FLOK:
    s_mul_i32 s49, s67, 1280
    s_add_u32 s49, s49, 524288
    s_mov_b32 exec_lo, 0xff000000
    s_mov_b32 exec_hi, 0xff000000
    buffer_store_dwordx4 v[64:67], v133, s[40:43], s49 offen sc1
    buffer_store_dwordx4 v[80:83], v133, s[40:43], s49 offen offset:256 sc1
    buffer_store_dwordx2 v[84:85], v134, s[40:43], s49 offen offset:512 sc1
    buffer_store_dwordx4 v[72:75], v133, s[40:43], s49 offen offset:640 sc1
    buffer_store_dwordx4 v[88:91], v133, s[40:43], s49 offen offset:896 sc1
    buffer_store_dwordx2 v[92:93], v134, s[40:43], s49 offen offset:1152 sc1
    s_mov_b64 exec, -1
    v_exp_f32 v14, v14
    v_exp_f32 v15, v15
    v_lshrrev_b32 v4, 1, v6
    v_add_f32 v14, 1.0, v14
    v_add_f32 v15, 1.0, v15
    v_rcp_f32 v14, v14
    v_rcp_f32 v15, v15
    v_mov_b32 v1, v14
    v_mov_b32 v2, v15
    v_mov_b32 v96, v84
    v_mov_b32 v97, v85
    v_mov_b32 v98, v92
    v_mov_b32 v99, v93
    v_permlane32_swap_b32 v1, v14
    v_permlane32_swap_b32 v2, v15
    s_mov_b32 exec_lo, 0xffffffff
    s_mov_b32 exec_hi, 0x0
    v_mov_b32 v96, 0x3f80
    v_mov_b32 v97, 0
    v_mov_b32 v98, 0x3f80
    v_mov_b32 v99, 0
    ds_write_b32 v4, v14 offset:256
    ds_write_b32 v4, v15 offset:384
    s_mov_b32 exec_lo, 0x0
    s_mov_b32 exec_hi, 0xffffffff
    v_mov_b32 v86, 0
    v_mov_b32 v87, 0
    v_mov_b32 v94, 0
    v_mov_b32 v95, 0
    s_mov_b64 exec, -1
    v_sub_f32 v14, 1.0, v14
    v_sub_f32 v15, 1.0, v15
    s_mov_b32 s48, 0
F_SB18:
    ds_read_b32 v4, v9 offset:8
    s_waitcnt lgkmcnt(0)
    v_readfirstlane_b32 s47, v4
    s_add_u32 s48, s48, 1
    s_cmp_ge_u32 s48, 1048576
    s_cbranch_scc1 F_SBX19
    s_cmp_ge_u32 s47, s57
    s_cbranch_scc1 F_SBX19
    s_sleep 2
    s_branch F_SB18
F_SBX19:
    ds_write_b64 v141, v[80:81]
    ds_write_b64 v141, v[82:83] offset:16
    ds_write_b64 v142, v[96:97] offset:40
    ds_read_b64_tr_b16 v[32:33], v5 offset:0
    ds_read_b64_tr_b16 v[34:35], v5 offset:384
    ds_read_b64_tr_b16 v[36:37], v5 offset:768
    ds_read_b64_tr_b16 v[38:39], v5 offset:1152
    ds_write_b64 v141, v[88:89]
    ds_write_b64 v141, v[90:91] offset:16
    ds_write_b64 v142, v[98:99] offset:40
    ds_read_b64_tr_b16 v[40:41], v5 offset:0
    ds_read_b64_tr_b16 v[42:43], v5 offset:384
    ds_read_b64_tr_b16 v[44:45], v5 offset:768
    ds_read_b64_tr_b16 v[46:47], v5 offset:1152
    v_mov_b32 v112, -1
    v_mov_b32 v113, -1
    v_mov_b32 v114, -1
    v_mov_b32 v115, -1
    s_sub_u32 s49, s62, 2621440
    s_add_u32 s50, s49, 40960
    buffer_store_dwordx4 v[112:115], v7, s[40:43], s49 offen sc1
    buffer_store_dwordx4 v[112:115], v7, s[40:43], s50 offen sc1
    s_mov_b32 exec_lo, 0xffff
    s_mov_b32 exec_hi, 0x0
    buffer_store_dwordx4 v[112:115], v7, s[40:43], s49 offen offset:1024 sc1
    buffer_store_dwordx4 v[112:115], v7, s[40:43], s50 offen offset:1024 sc1
    s_mov_b64 exec, -1
    s_cmp_ge_u32 s45, 1
    s_cbranch_scc1 F_H_HL0
    v_mov_b32 v16, 0
    v_mov_b32 v17, 0
    v_mov_b32 v18, 0
    v_mov_b32 v19, 0
    v_mov_b32 v20, 0
    v_mov_b32 v21, 0
    v_mov_b32 v22, 0
    v_mov_b32 v23, 0
    v_mov_b32 v24, 0
    v_mov_b32 v25, 0
    v_mov_b32 v26, 0
    v_mov_b32 v27, 0
    v_mov_b32 v28, 0
    v_mov_b32 v29, 0
    v_mov_b32 v30, 0
    v_mov_b32 v31, 0
    v_mov_b32 v144, 0
    v_mov_b32 v145, 0
    v_mov_b32 v146, 0
    v_mov_b32 v147, 0
    s_waitcnt vmcnt(0)
    s_branch F_H_HOK
F_H_HL0:
    s_mul_i32 s49, s67, 1280
    s_add_u32 s49, s49, 483328
    s_mov_b32 s48, 0
    s_mov_b32 exec_lo, 0xff000000
    s_mov_b32 exec_hi, 0xff000000
F_H_HL:
    buffer_load_dwordx4 v[16:19], v133, s[40:43], s49 offen sc1
    buffer_load_dwordx4 v[24:27], v133, s[40:43], s49 offen offset:256 sc1
    buffer_load_dwordx2 v[144:145], v134, s[40:43], s49 offen offset:512 sc1
    buffer_load_dwordx4 v[20:23], v133, s[40:43], s49 offen offset:640 sc1
    buffer_load_dwordx4 v[28:31], v133, s[40:43], s49 offen offset:896 sc1
    buffer_load_dwordx2 v[146:147], v134, s[40:43], s49 offen offset:1152 sc1
    s_waitcnt vmcnt(0)
    v_max3_u32 v1, v16, v17, v18
    v_max3_u32 v2, v19, v20, v21
    v_max3_u32 v1, v1, v22, v23
    v_max3_u32 v2, v2, v24, v25
    v_max3_u32 v1, v1, v26, v27
    v_max3_u32 v2, v2, v28, v29
    v_max3_u32 v1, v1, v30, v31
    v_max3_u32 v2, v2, v144, v145
    v_max3_u32 v1, v1, v146, v147
    v_max_u32 v1, v1, v2
    v_cmp_eq_u32 vcc, -1, v1
    s_add_u32 s48, s48, 1
    s_cbranch_vccz F_H_HL1
    s_cmp_ge_u32 s48, 65536
    s_cbranch_scc1 F_H_HL1
    s_sleep 4
    s_branch F_H_HL
F_H_HL1:
    s_mov_b64 exec, -1
F_H_HOK:
    s_mov_b32 m0, s58
    s_nop 0
    buffer_load_dwordx4 v128, s[32:35], s59 offen lds
    s_mul_i32 s58, s53, 5120
    s_add_u32 s58, s58, 10240
    s_mul_i32 s59, s53, 51200
    s_add_u32 s59, s59, 204800
    s_mov_b32 m0, s58
    s_nop 0
    buffer_load_dwordx4 v128, s[32:35], s59 offen lds
    buffer_load_dwordx4 v129, s[32:35], s59 offen offset:1024 lds
    buffer_load_dwordx4 v130, s[32:35], s59 offen offset:2048 lds
    buffer_load_dwordx4 v131, s[32:35], s59 offen offset:3072 lds
    s_add_u32 m0, s58, 4096
    s_nop 0
    buffer_load_dwordx4 v132, s[32:35], s59 offen lds
    s_add_u32 s58, s58, 20480
    s_cmp_ge_u32 s53, 2
    s_cbranch_scc1 F_H6
    s_add_u32 s49, s58, 40960
    s_mul_i32 s52, s53, 204800
    s_mov_b32 m0, s49
    s_nop 0
    buffer_load_dwordx4 v136, s[32:35], s52 offen lds
    buffer_load_dwordx4 v137, s[32:35], s52 offen offset:1024 lds
    buffer_load_dwordx4 v138, s[32:35], s52 offen offset:2048 lds
    buffer_load_dwordx4 v139, s[32:35], s52 offen offset:3072 lds
    s_add_u32 m0, s49, 4096
    s_nop 0
    buffer_load_dwordx4 v140, s[32:35], s52 offen lds
F_H6:
    s_mov_b32 exec_lo, 0x0
    s_mov_b32 exec_hi, 0xffffffff
    v_mov_b32 v96, v144
    v_mov_b32 v97, v145
    v_mov_b32 v98, v146
    v_mov_b32 v99, v147
    s_mov_b32 exec_lo, 0xff000000
    s_mov_b32 exec_hi, 0xff000000
    ds_write_b64 v141, v[24:25] offset:0
    ds_write_b64 v141, v[26:27] offset:16
    ds_write_b64 v142, v[96:97] offset:40
    ds_write_b64 v141, v[28:29] offset:384
    ds_write_b64 v141, v[30:31] offset:400
    ds_write_b64 v142, v[98:99] offset:424
    s_mov_b64 exec, -1
    ds_read_b64_tr_b16 v[58:59], v5 offset:1152
    ds_read_b64_tr_b16 v[60:61], v5 offset:1536
    s_waitcnt lgkmcnt(0)
    v_mfma_f32_32x32x16_bf16 v[96:111], v[64:67], v[68:71], v[148:163]
    v_mfma_f32_32x32x16_bf16 v[112:127], v[16:19], v[68:71], v[152:167]
    v_mfma_f32_32x32x8_bf16 v[96:111], v[84:85], v[86:87], v[96:111]
    v_mfma_f32_32x32x8_bf16 v[112:127], v[144:145], v[86:87], v[112:127]
    s_add_u32 s59, s59, 204800
    s_mov_b32 m0, s58
    s_nop 0
    buffer_load_dwordx4 v128, s[32:35], s59 offen lds
    buffer_load_dwordx4 v129, s[32:35], s59 offen offset:1024 lds
    buffer_load_dwordx4 v130, s[32:35], s59 offen offset:2048 lds
    buffer_load_dwordx4 v131, s[32:35], s59 offen offset:3072 lds
    s_add_u32 m0, s58, 4096
    s_nop 0
    buffer_load_dwordx4 v132, s[32:35], s59 offen lds
    s_add_u32 s58, s58, 20480
    s_nop 3
    v_max3_f32 v1, v96, v97, v98
    v_max3_f32 v2, v99, v100, v101
    v_max3_f32 v1, v1, v102, v103
    v_max3_f32 v2, v2, v104, v105
    v_max3_f32 v1, v1, v106, v107
    v_max3_f32 v2, v2, v108, v109
    v_max3_f32 v1, v1, v110, v111
    v_max3_f32 v2, v2, v124, v125
    v_max3_f32 v1, v1, v126, v127
    v_max_f32 v1, v1, v2
    v_mov_b32 v2, v1
    s_nop 1
    v_permlane32_swap_b32 v1, v2
    s_nop 1
    v_max_f32 v1, v1, v2
    v_mul_f32 v1, s60, v1
    v_fma_f32 v96, v96, s60, -v1
    v_fma_f32 v97, v97, s60, -v1
    v_fma_f32 v98, v98, s60, -v1
    v_fma_f32 v99, v99, s60, -v1
    v_fma_f32 v100, v100, s60, -v1
    v_fma_f32 v101, v101, s60, -v1
    v_fma_f32 v102, v102, s60, -v1
    v_fma_f32 v103, v103, s60, -v1
    v_fma_f32 v104, v104, s60, -v1
    v_fma_f32 v105, v105, s60, -v1
    v_fma_f32 v106, v106, s60, -v1
    v_fma_f32 v107, v107, s60, -v1
    v_fma_f32 v108, v108, s60, -v1
    v_fma_f32 v109, v109, s60, -v1
    v_fma_f32 v110, v110, s60, -v1
    v_fma_f32 v111, v111, s60, -v1
    v_fma_f32 v124, v124, s60, -v1
    v_fma_f32 v125, v125, s60, -v1
    v_fma_f32 v126, v126, s60, -v1
    v_fma_f32 v127, v127, s60, -v1
    v_exp_f32 v96, v96
    v_exp_f32 v97, v97
    v_exp_f32 v98, v98
    v_exp_f32 v99, v99
    v_exp_f32 v100, v100
    v_exp_f32 v101, v101
    v_exp_f32 v102, v102
    v_exp_f32 v103, v103
    v_exp_f32 v104, v104
    v_exp_f32 v105, v105
    v_exp_f32 v106, v106
    v_exp_f32 v107, v107
    v_exp_f32 v108, v108
    v_exp_f32 v109, v109
    v_exp_f32 v110, v110
    v_exp_f32 v111, v111
    v_exp_f32 v124, v124
    v_exp_f32 v125, v125
    v_exp_f32 v126, v126
    v_exp_f32 v127, v127
    v_cvt_pk_bf16_f32 v48, v96, v97
    v_cvt_pk_bf16_f32 v49, v98, v99
    v_cvt_pk_bf16_f32 v50, v100, v101
    v_cvt_pk_bf16_f32 v51, v102, v103
    v_cvt_pk_bf16_f32 v52, v104, v105
    v_cvt_pk_bf16_f32 v53, v106, v107
    v_cvt_pk_bf16_f32 v54, v108, v109
    v_cvt_pk_bf16_f32 v55, v110, v111
    v_cvt_pk_bf16_f32 v56, v124, v125
    v_cvt_pk_bf16_f32 v57, v126, v127
    s_nop 1
    v_mfma_f32_32x32x16_bf16 v[96:111], v[32:35], v[48:51], 0
    v_mfma_f32_32x32x16_bf16 v[96:111], v[36:39], v[52:55], v[96:111]
    v_mfma_f32_32x32x8_bf16 v[96:111], v[58:59], v[56:57], v[96:111]
    s_nop 7
    s_nop 3
    v_mov_b32 v1, v104
    v_mov_b32 v2, v104
    s_nop 1
    v_permlane32_swap_b32 v1, v2
    s_nop 1
    v_rcp_f32 v1, v2
    s_nop 0
    v_mul_f32 v1, v1, v14
    v_mul_f32 v96, v96, v1
    v_mul_f32 v97, v97, v1
    v_mul_f32 v98, v98, v1
    v_mul_f32 v99, v99, v1
    v_mul_f32 v100, v100, v1
    v_mul_f32 v101, v101, v1
    v_mul_f32 v102, v102, v1
    v_mul_f32 v103, v103, v1
    v_mul_f32 v104, v104, v1
    v_mul_f32 v105, v105, v1
    v_mul_f32 v106, v106, v1
    v_mul_f32 v107, v107, v1
    v_cvt_pk_bf16_f32 v68, v104, v105
    v_cvt_pk_bf16_f32 v69, v106, v107
    v_cvt_pk_bf16_f32 v64, v96, v97
    v_cvt_pk_bf16_f32 v65, v98, v99
    v_cvt_pk_bf16_f32 v66, v100, v101
    v_cvt_pk_bf16_f32 v67, v102, v103
    v_mov_b32_dpp v70, v68 quad_perm:[1,1,3,3] row_mask:0xf bank_mask:0xf
    v_mov_b32_dpp v71, v69 quad_perm:[1,1,3,3] row_mask:0xf bank_mask:0xf
    buffer_store_dwordx4 v[64:67], v7, s[40:43], s62 offen sc1
    s_mov_b32 exec_lo, 0x55555555
    s_mov_b32 exec_hi, 0x0
    buffer_store_dwordx4 v[68:71], v6, s[40:43], s62 offen offset:1024 sc1
    s_mov_b64 exec, -1
    s_add_u32 s62, s62, 40960
    v_mfma_f32_32x32x16_bf16 v[96:111], v[72:75], v[76:79], v[148:163]
    v_mfma_f32_32x32x16_bf16 v[112:127], v[20:23], v[76:79], v[152:167]
    v_mfma_f32_32x32x8_bf16 v[96:111], v[92:93], v[94:95], v[96:111]
    v_mfma_f32_32x32x8_bf16 v[112:127], v[146:147], v[94:95], v[112:127]
    s_add_u32 s59, s59, 204800
    s_mov_b32 m0, s58
    s_nop 0
    buffer_load_dwordx4 v128, s[32:35], s59 offen lds
    buffer_load_dwordx4 v129, s[32:35], s59 offen offset:1024 lds
    buffer_load_dwordx4 v130, s[32:35], s59 offen offset:2048 lds
    buffer_load_dwordx4 v131, s[32:35], s59 offen offset:3072 lds
    s_add_u32 m0, s58, 4096
    s_nop 0
    buffer_load_dwordx4 v132, s[32:35], s59 offen lds
    s_add_u32 s58, s58, 20480
    s_nop 3
    v_max3_f32 v1, v96, v97, v98
    v_max3_f32 v2, v99, v100, v101
    v_max3_f32 v1, v1, v102, v103
    v_max3_f32 v2, v2, v104, v105
    v_max3_f32 v1, v1, v106, v107
    v_max3_f32 v2, v2, v108, v109
    v_max3_f32 v1, v1, v110, v111
    v_max3_f32 v2, v2, v124, v125
    v_max3_f32 v1, v1, v126, v127
    v_max_f32 v1, v1, v2
    v_mov_b32 v2, v1
    s_nop 1
    v_permlane32_swap_b32 v1, v2
    s_nop 1
    v_max_f32 v1, v1, v2
    v_mul_f32 v1, s60, v1
    v_fma_f32 v96, v96, s60, -v1
    v_fma_f32 v97, v97, s60, -v1
    v_fma_f32 v98, v98, s60, -v1
    v_fma_f32 v99, v99, s60, -v1
    v_fma_f32 v100, v100, s60, -v1
    v_fma_f32 v101, v101, s60, -v1
    v_fma_f32 v102, v102, s60, -v1
    v_fma_f32 v103, v103, s60, -v1
    v_fma_f32 v104, v104, s60, -v1
    v_fma_f32 v105, v105, s60, -v1
    v_fma_f32 v106, v106, s60, -v1
    v_fma_f32 v107, v107, s60, -v1
    v_fma_f32 v108, v108, s60, -v1
    v_fma_f32 v109, v109, s60, -v1
    v_fma_f32 v110, v110, s60, -v1
    v_fma_f32 v111, v111, s60, -v1
    v_fma_f32 v124, v124, s60, -v1
    v_fma_f32 v125, v125, s60, -v1
    v_fma_f32 v126, v126, s60, -v1
    v_fma_f32 v127, v127, s60, -v1
    v_exp_f32 v96, v96
    v_exp_f32 v97, v97
    v_exp_f32 v98, v98
    v_exp_f32 v99, v99
    v_exp_f32 v100, v100
    v_exp_f32 v101, v101
    v_exp_f32 v102, v102
    v_exp_f32 v103, v103
    v_exp_f32 v104, v104
    v_exp_f32 v105, v105
    v_exp_f32 v106, v106
    v_exp_f32 v107, v107
    v_exp_f32 v108, v108
    v_exp_f32 v109, v109
    v_exp_f32 v110, v110
    v_exp_f32 v111, v111
    v_exp_f32 v124, v124
    v_exp_f32 v125, v125
    v_exp_f32 v126, v126
    v_exp_f32 v127, v127
    v_cvt_pk_bf16_f32 v48, v96, v97
    v_cvt_pk_bf16_f32 v49, v98, v99
    v_cvt_pk_bf16_f32 v50, v100, v101
    v_cvt_pk_bf16_f32 v51, v102, v103
    v_cvt_pk_bf16_f32 v52, v104, v105
    v_cvt_pk_bf16_f32 v53, v106, v107
    v_cvt_pk_bf16_f32 v54, v108, v109
    v_cvt_pk_bf16_f32 v55, v110, v111
    v_cvt_pk_bf16_f32 v56, v124, v125
    v_cvt_pk_bf16_f32 v57, v126, v127
    s_nop 1
    v_mfma_f32_32x32x16_bf16 v[96:111], v[40:43], v[48:51], 0
    v_mfma_f32_32x32x16_bf16 v[96:111], v[44:47], v[52:55], v[96:111]
    v_mfma_f32_32x32x8_bf16 v[96:111], v[60:61], v[56:57], v[96:111]
    s_nop 7
    s_nop 3
    v_mov_b32 v1, v104
    v_mov_b32 v2, v104
    s_nop 1
    v_permlane32_swap_b32 v1, v2
    s_nop 1
    v_rcp_f32 v1, v2
    s_nop 0
    v_mul_f32 v1, v1, v15
    v_mul_f32 v96, v96, v1
    v_mul_f32 v97, v97, v1
    v_mul_f32 v98, v98, v1
    v_mul_f32 v99, v99, v1
    v_mul_f32 v100, v100, v1
    v_mul_f32 v101, v101, v1
    v_mul_f32 v102, v102, v1
    v_mul_f32 v103, v103, v1
    v_mul_f32 v104, v104, v1
    v_mul_f32 v105, v105, v1
    v_mul_f32 v106, v106, v1
    v_mul_f32 v107, v107, v1
    v_cvt_pk_bf16_f32 v76, v104, v105
    v_cvt_pk_bf16_f32 v77, v106, v107
    v_cvt_pk_bf16_f32 v72, v96, v97
    v_cvt_pk_bf16_f32 v73, v98, v99
    v_cvt_pk_bf16_f32 v74, v100, v101
    v_cvt_pk_bf16_f32 v75, v102, v103
    v_mov_b32_dpp v78, v76 quad_perm:[1,1,3,3] row_mask:0xf bank_mask:0xf
    v_mov_b32_dpp v79, v77 quad_perm:[1,1,3,3] row_mask:0xf bank_mask:0xf
    buffer_store_dwordx4 v[72:75], v7, s[40:43], s62 offen sc1
    s_mov_b32 exec_lo, 0x55555555
    s_mov_b32 exec_hi, 0x0
    buffer_store_dwordx4 v[76:79], v6, s[40:43], s62 offen offset:1024 sc1
    s_mov_b64 exec, -1
    s_waitcnt vmcnt(2)
    s_mov_b64 exec, 1
    ds_add_u32 v9, v8 offset:8
    s_mov_b64 exec, -1
    s_add_u32 s57, s57, 4
    v_mov_b32 v5, v143
    v_mov_b32 v6, v135
    s_mov_b32 s64, 0
    s_mov_b32 s56, 0xfffee800
F_OP:
    v_mov_b32 v3, 0
    s_mov_b32 s48, 0
F_SB20:
    ds_read_b32 v1, v3 offset:8
    s_waitcnt lgkmcnt(0)
    v_readfirstlane_b32 s47, v1
    s_add_u32 s48, s48, 1
    s_cmp_ge_u32 s48, 1048576
    s_cbranch_scc1 F_SBX21
    s_cmp_ge_u32 s47, s57
    s_cbranch_scc1 F_SBX21
    s_sleep 2
    s_branch F_SB20
F_SBX21:
    ds_read_b64_tr_b16 v[48:49], v5 offset:0
    ds_read_b64_tr_b16 v[50:51], v5 offset:2560
    ds_read_b64_tr_b16 v[52:53], v5 offset:32
    ds_read_b64_tr_b16 v[54:55], v5 offset:2592
    ds_read_b64_tr_b16 v[56:57], v5 offset:64
    ds_read_b64_tr_b16 v[58:59], v5 offset:2624
    ds_read_b64_tr_b16 v[60:61], v5 offset:96
    ds_read_b64_tr_b16 v[62:63], v5 offset:2656
    ds_read_b64_tr_b16 v[64:65], v5 offset:128
    ds_read_b64_tr_b16 v[66:67], v5 offset:2688
    ds_read_b64_tr_b16 v[68:69], v5 offset:10240
    ds_read_b64_tr_b16 v[70:71], v5 offset:12800
    ds_read_b64_tr_b16 v[72:73], v5 offset:10272
    ds_read_b64_tr_b16 v[74:75], v5 offset:12832
    ds_read_b64_tr_b16 v[76:77], v5 offset:10304
    ds_read_b64_tr_b16 v[78:79], v5 offset:12864
    ds_read_b64_tr_b16 v[80:81], v5 offset:10336
    ds_read_b64_tr_b16 v[82:83], v5 offset:12896
    ds_read_b64_tr_b16 v[84:85], v5 offset:10368
    ds_read_b64_tr_b16 v[86:87], v5 offset:12928
    v_lshrrev_b32 v4, 4, v0
    v_mul_u32_u24 v4, 2432, v4
    v_lshl_add_u32 v4, v0, 3, v4
    s_lshr_b32 s47, s53, 1
    s_mul_i32 s58, s47, 2560
    s_add_u32 s58, s58, s65
    s_mul_i32 s59, s47, 10240
    s_add_u32 s59, s59, s65
    s_cmp_lg_u32 s64, 0
    s_cbranch_scc1 F_OP_A
    ds_write_b128 v7, v[128:131] offset:512
    ds_write_b32 v7, v132 offset:1536
    s_waitcnt lgkmcnt(0)
    v_mov_b32 v3, 0
    v_mov_b32 v2, 1
    s_mov_b64 exec, 1
    ds_add_u32 v3, v2 offset:8
    s_mov_b64 exec, -1
    s_add_u32 s57, s57, 4
    s_mul_i32 s49, s53, 5120
    s_add_u32 s49, s49, 81920
    v_mov_b32 v3, 0
    s_mov_b32 s48, 0
F_SB22:
    ds_read_b32 v1, v3 offset:8
    s_waitcnt lgkmcnt(0)
    v_readfirstlane_b32 s47, v1
    s_add_u32 s48, s48, 1
    s_cmp_ge_u32 s48, 1048576
    s_cbranch_scc1 F_SBX23
    s_cmp_ge_u32 s47, s57
    s_cbranch_scc1 F_SBX23
    s_sleep 2
    s_branch F_SB22
F_SBX23:
    s_cmp_ge_u32 s53, 2
    s_cbranch_scc1 F_OP1
    s_mul_i32 s50, s53, 204800
    s_add_u32 s50, s50, 409600
    s_mov_b32 m0, s49
    s_nop 0
    buffer_load_dwordx4 v136, s[32:35], s50 offen lds
    buffer_load_dwordx4 v137, s[32:35], s50 offen offset:1024 lds
    buffer_load_dwordx4 v138, s[32:35], s50 offen offset:2048 lds
    buffer_load_dwordx4 v139, s[32:35], s50 offen offset:3072 lds
    s_add_u32 m0, s49, 4096
    s_nop 0
    buffer_load_dwordx4 v140, s[32:35], s50 offen lds
    s_branch F_OP2
F_OP1:
    s_mul_i32 s50, s53, 51200
    s_add_u32 s50, s50, 204800
    s_mov_b32 m0, s49
    s_nop 0
    buffer_load_dwordx4 v128, s[28:31], s50 offen lds
    buffer_load_dwordx4 v129, s[28:31], s50 offen offset:1024 lds
    buffer_load_dwordx4 v130, s[28:31], s50 offen offset:2048 lds
    buffer_load_dwordx4 v131, s[28:31], s50 offen offset:3072 lds
    s_add_u32 m0, s49, 4096
    s_nop 0
    buffer_load_dwordx4 v132, s[28:31], s50 offen lds
F_OP2:
    v_and_b32 v1, 31, v0
    v_mul_u32_u24 v1, 1280, v1
    s_mov_b32 s48, 0
F_OP_PL:
    buffer_load_dword v2, v1, s[40:43], s65 offen offset:1276 sc1
    s_waitcnt vmcnt(0)
    v_cmp_eq_u32 vcc, -1, v2
    s_add_u32 s48, s48, 1
    s_cbranch_vccz F_OP_GO
    s_cmp_ge_u32 s48, 65536
    s_cbranch_scc1 F_OP_GO
    s_sleep 4
    s_branch F_OP_PL
F_OP_A:
    v_mov_b32 v2, 1
    s_waitcnt lgkmcnt(0)
    s_mov_b64 exec, 1
    ds_add_u32 v3, v2 offset:16
    s_mov_b64 exec, -1
    s_cmp_ge_u32 s53, 2
    s_cbranch_scc1 F_OP3
    s_mul_i32 s49, s53, 5120
    s_add_u32 s49, s49, 81920
    s_mul_i32 s50, s53, 51200
    s_add_u32 s50, s50, 204800
    s_mov_b32 m0, s49
    s_nop 0
    buffer_load_dwordx4 v88, s[28:31], s50 offen lds
    buffer_load_dwordx4 v89, s[28:31], s50 offen offset:1024 lds
    buffer_load_dwordx4 v90, s[28:31], s50 offen offset:2048 lds
    buffer_load_dwordx4 v91, s[28:31], s50 offen offset:3072 lds
    s_add_u32 m0, s49, 4096
    s_nop 0
    buffer_load_dwordx4 v92, s[28:31], s50 offen lds
F_OP3:
    s_mov_b32 s32, s22
    s_and_b32 s33, s23, 0xffff
    s_mov_b32 s34, 2621440
    s_mov_b32 s35, 0x00020000
    s_xor_b32 s47, s53, 2
    s_mul_i32 s47, s47, 5120
    s_add_u32 s51, s47, 8192
    s_mul_i32 s47, s53, 5120
    s_add_u32 s52, s47, 8192
    s_lshl_b32 s47, s45, 6
    s_and_b32 s48, s53, 1
    s_add_u32 s47, s47, s48
    s_lshr_b32 s48, s53, 1
    s_lshl_b32 s49, s48, 5
    s_add_u32 s47, s47, s49
    s_mul_i32 s47, s47, 1280
    s_mul_i32 s49, s46, 160
    s_add_u32 s62, s47, s49
    s_barrier
    s_waitcnt vmcnt(0)
    s_barrier
    v_mov_b32 v1, 0
    ds_read_b128 v[88:91], v1 offset:32
    ds_read_b128 v[92:95], v1 offset:48
    s_waitcnt lgkmcnt(0)
    v_or3_b32 v88, v88, v89, v90
    v_or3_b32 v91, v91, v92, v93
    v_or3_b32 v88, v88, v94, v95
    v_or_b32 v88, v88, v91
    s_nop 0
    v_readfirstlane_b32 s47, v88
    s_cmp_eq_u32 s47, 0
    s_cbranch_scc1 F_OP_GO
    s_barrier
    s_barrier
    s_barrier
F_OP_GO:
    s_add_u32 s47, s58, 0
    buffer_load_dwordx4 v[88:91], v6, s[40:43], s47 offen sc1
    buffer_load_dwordx4 v[92:95], v6, s[40:43], s47 offen offset:256 sc1
    s_add_u32 s47, s58, 5120
    buffer_load_dwordx4 v[96:99], v6, s[40:43], s47 offen sc1
    buffer_load_dwordx4 v[100:103], v6, s[40:43], s47 offen offset:256 sc1
    s_add_u32 s47, s58, 10240
    buffer_load_dwordx4 v[104:107], v6, s[40:43], s47 offen sc1
    buffer_load_dwordx4 v[108:111], v6, s[40:43], s47 offen offset:256 sc1
    s_add_u32 s47, s58, 15360
    buffer_load_dwordx4 v[112:115], v6, s[40:43], s47 offen sc1
    buffer_load_dwordx4 v[116:119], v6, s[40:43], s47 offen offset:256 sc1
    s_mov_b32 s66, 0
F_OC0:
    s_waitcnt vmcnt(6)
    v_max3_u32 v1, v88, v89, v90
    v_max3_u32 v2, v91, v92, v93
    v_max3_u32 v1, v1, v94, v95
    v_max_u32 v1, v1, v2
    v_cmp_eq_u32 vcc, -1, v1
    s_waitcnt lgkmcnt(10)
    s_cbranch_vccnz F_OR0
F_OG0:
    s_cmp_lg_u32 s64, 0
    s_cbranch_scc1 F_OG0A
    v_mfma_f32_16x16x32_bf16 v[8:11], v[48:51], v[88:91], 0
    v_mfma_f32_16x16x32_bf16 v[12:15], v[48:51], v[92:95], 0
    s_add_u32 s47, s58, 20480
    buffer_load_dwordx4 v[120:123], v6, s[40:43], s47 offen sc1
    buffer_load_dwordx4 v[124:127], v6, s[40:43], s47 offen offset:256 sc1
    v_mfma_f32_16x16x32_bf16 v[16:19], v[52:55], v[88:91], 0
    v_mfma_f32_16x16x32_bf16 v[20:23], v[52:55], v[92:95], 0
    v_add_u32 v5, s56, v5
    ds_read_b64_tr_b16 v[48:49], v5 offset:0
    ds_read_b64_tr_b16 v[50:51], v5 offset:2560
    v_mfma_f32_16x16x32_bf16 v[24:27], v[56:59], v[88:91], 0
    v_mfma_f32_16x16x32_bf16 v[28:31], v[56:59], v[92:95], 0
    ds_read_b64_tr_b16 v[52:53], v5 offset:32
    ds_read_b64_tr_b16 v[54:55], v5 offset:2592
    v_mfma_f32_16x16x32_bf16 v[32:35], v[60:63], v[88:91], 0
    v_mfma_f32_16x16x32_bf16 v[36:39], v[60:63], v[92:95], 0
    ds_read_b64_tr_b16 v[56:57], v5 offset:64
    ds_read_b64_tr_b16 v[58:59], v5 offset:2624
    v_mfma_f32_16x16x32_bf16 v[40:43], v[64:67], v[88:91], 0
    v_mfma_f32_16x16x32_bf16 v[44:47], v[64:67], v[92:95], 0
    ds_read_b64_tr_b16 v[60:61], v5 offset:96
    ds_read_b64_tr_b16 v[62:63], v5 offset:2656
    ds_read_b64_tr_b16 v[64:65], v5 offset:128
    ds_read_b64_tr_b16 v[66:67], v5 offset:2688
    s_branch F_OG0B
F_OG0A:
    v_mfma_f32_16x16x32_bf16 v[8:11], v[48:51], v[88:91], v[8:11]
    v_mfma_f32_16x16x32_bf16 v[12:15], v[48:51], v[92:95], v[12:15]
    s_add_u32 s47, s58, 20480
    buffer_load_dwordx4 v[120:123], v6, s[40:43], s47 offen sc1
    buffer_load_dwordx4 v[124:127], v6, s[40:43], s47 offen offset:256 sc1
    v_mfma_f32_16x16x32_bf16 v[16:19], v[52:55], v[88:91], v[16:19]
    v_mfma_f32_16x16x32_bf16 v[20:23], v[52:55], v[92:95], v[20:23]
    v_add_u32 v5, s56, v5
    ds_read_b64_tr_b16 v[48:49], v5 offset:0
    ds_read_b64_tr_b16 v[50:51], v5 offset:2560
    v_mfma_f32_16x16x32_bf16 v[24:27], v[56:59], v[88:91], v[24:27]
    v_mfma_f32_16x16x32_bf16 v[28:31], v[56:59], v[92:95], v[28:31]
    ds_read_b64_tr_b16 v[52:53], v5 offset:32
    ds_read_b64_tr_b16 v[54:55], v5 offset:2592
    v_mfma_f32_16x16x32_bf16 v[32:35], v[60:63], v[88:91], v[32:35]
    v_mfma_f32_16x16x32_bf16 v[36:39], v[60:63], v[92:95], v[36:39]
    ds_read_b64_tr_b16 v[56:57], v5 offset:64
    ds_read_b64_tr_b16 v[58:59], v5 offset:2624
    v_mfma_f32_16x16x32_bf16 v[40:43], v[64:67], v[88:91], v[40:43]
    v_mfma_f32_16x16x32_bf16 v[44:47], v[64:67], v[92:95], v[44:47]
    ds_read_b64_tr_b16 v[60:61], v5 offset:96
    ds_read_b64_tr_b16 v[62:63], v5 offset:2656
    ds_read_b64_tr_b16 v[64:65], v5 offset:128
    ds_read_b64_tr_b16 v[66:67], v5 offset:2688
F_OG0B:
F_OC1:
    s_waitcnt vmcnt(6)
    v_max3_u32 v1, v96, v97, v98
    v_max3_u32 v2, v99, v100, v101
    v_max3_u32 v1, v1, v102, v103
    v_max_u32 v1, v1, v2
    v_cmp_eq_u32 vcc, -1, v1
    s_waitcnt lgkmcnt(10)
    s_cbranch_vccnz F_OR1
F_OG1:
    v_mfma_f32_16x16x32_bf16 v[8:11], v[68:71], v[96:99], v[8:11]
    v_mfma_f32_16x16x32_bf16 v[12:15], v[68:71], v[100:103], v[12:15]
    s_add_u32 s47, s58, 25600
    buffer_load_dwordx4 v[128:131], v6, s[40:43], s47 offen sc1
    buffer_load_dwordx4 v[132:135], v6, s[40:43], s47 offen offset:256 sc1
    v_mfma_f32_16x16x32_bf16 v[16:19], v[72:75], v[96:99], v[16:19]
    v_mfma_f32_16x16x32_bf16 v[20:23], v[72:75], v[100:103], v[20:23]
    ds_read_b64_tr_b16 v[68:69], v5 offset:10240
    ds_read_b64_tr_b16 v[70:71], v5 offset:12800
    v_mfma_f32_16x16x32_bf16 v[24:27], v[76:79], v[96:99], v[24:27]
    v_mfma_f32_16x16x32_bf16 v[28:31], v[76:79], v[100:103], v[28:31]
    ds_read_b64_tr_b16 v[72:73], v5 offset:10272
    ds_read_b64_tr_b16 v[74:75], v5 offset:12832
    v_mfma_f32_16x16x32_bf16 v[32:35], v[80:83], v[96:99], v[32:35]
    v_mfma_f32_16x16x32_bf16 v[36:39], v[80:83], v[100:103], v[36:39]
    ds_read_b64_tr_b16 v[76:77], v5 offset:10304
    ds_read_b64_tr_b16 v[78:79], v5 offset:12864
    v_mfma_f32_16x16x32_bf16 v[40:43], v[84:87], v[96:99], v[40:43]
    v_mfma_f32_16x16x32_bf16 v[44:47], v[84:87], v[100:103], v[44:47]
    ds_read_b64_tr_b16 v[80:81], v5 offset:10336
    ds_read_b64_tr_b16 v[82:83], v5 offset:12896
    ds_read_b64_tr_b16 v[84:85], v5 offset:10368
    ds_read_b64_tr_b16 v[86:87], v5 offset:12928
F_OC2:
    s_waitcnt vmcnt(6)
    v_max3_u32 v1, v104, v105, v106
    v_max3_u32 v2, v107, v108, v109
    v_max3_u32 v1, v1, v110, v111
    v_max_u32 v1, v1, v2
    v_cmp_eq_u32 vcc, -1, v1
    s_waitcnt lgkmcnt(10)
    s_cbranch_vccnz F_OR2
F_OG2:
    v_mfma_f32_16x16x32_bf16 v[8:11], v[48:51], v[104:107], v[8:11]
    v_mfma_f32_16x16x32_bf16 v[12:15], v[48:51], v[108:111], v[12:15]
    s_add_u32 s47, s58, 30720
    buffer_load_dwordx4 v[136:139], v6, s[40:43], s47 offen sc1
    buffer_load_dwordx4 v[140:143], v6, s[40:43], s47 offen offset:256 sc1
    v_mfma_f32_16x16x32_bf16 v[16:19], v[52:55], v[104:107], v[16:19]
    v_mfma_f32_16x16x32_bf16 v[20:23], v[52:55], v[108:111], v[20:23]
    ds_read_b64_tr_b16 v[48:49], v5 offset:20480
    ds_read_b64_tr_b16 v[50:51], v5 offset:23040
    v_mfma_f32_16x16x32_bf16 v[24:27], v[56:59], v[104:107], v[24:27]
    v_mfma_f32_16x16x32_bf16 v[28:31], v[56:59], v[108:111], v[28:31]
    ds_read_b64_tr_b16 v[52:53], v5 offset:20512
    ds_read_b64_tr_b16 v[54:55], v5 offset:23072
    v_mfma_f32_16x16x32_bf16 v[32:35], v[60:63], v[104:107], v[32:35]
    v_mfma_f32_16x16x32_bf16 v[36:39], v[60:63], v[108:111], v[36:39]
    ds_read_b64_tr_b16 v[56:57], v5 offset:20544
    ds_read_b64_tr_b16 v[58:59], v5 offset:23104
    v_mfma_f32_16x16x32_bf16 v[40:43], v[64:67], v[104:107], v[40:43]
    v_mfma_f32_16x16x32_bf16 v[44:47], v[64:67], v[108:111], v[44:47]
    ds_read_b64_tr_b16 v[60:61], v5 offset:20576
    ds_read_b64_tr_b16 v[62:63], v5 offset:23136
    ds_read_b64_tr_b16 v[64:65], v5 offset:20608
    ds_read_b64_tr_b16 v[66:67], v5 offset:23168
F_OC3:
    s_waitcnt vmcnt(6)
    v_max3_u32 v1, v112, v113, v114
    v_max3_u32 v2, v115, v116, v117
    v_max3_u32 v1, v1, v118, v119
    v_max_u32 v1, v1, v2
    v_cmp_eq_u32 vcc, -1, v1
    s_waitcnt lgkmcnt(10)
    s_cbranch_vccnz F_OR3
F_OG3:
    s_cmp_lg_u32 s64, 0
    s_cbranch_scc1 F_OG3A
    v_mov_b32 v3, 0
    v_mov_b32 v2, 1
    s_mov_b64 exec, 1
    ds_add_u32 v3, v2 offset:8
    s_mov_b64 exec, -1
    s_add_u32 s57, s57, 4
    ds_read_b128 v[88:91], v7 offset:512
    ds_read_b32 v92, v7 offset:1536
F_OG3A:
    v_mfma_f32_16x16x32_bf16 v[8:11], v[68:71], v[112:115], v[8:11]
    v_mfma_f32_16x16x32_bf16 v[12:15], v[68:71], v[116:119], v[12:15]
    s_add_u32 s47, s58, 35840
    buffer_load_dwordx4 v[144:147], v6, s[40:43], s47 offen sc1
    buffer_load_dwordx4 v[148:151], v6, s[40:43], s47 offen offset:256 sc1
    v_mfma_f32_16x16x32_bf16 v[16:19], v[72:75], v[112:115], v[16:19]
    v_mfma_f32_16x16x32_bf16 v[20:23], v[72:75], v[116:119], v[20:23]
    ds_read_b64_tr_b16 v[68:69], v5 offset:30720
    ds_read_b64_tr_b16 v[70:71], v5 offset:33280
    v_mfma_f32_16x16x32_bf16 v[24:27], v[76:79], v[112:115], v[24:27]
    v_mfma_f32_16x16x32_bf16 v[28:31], v[76:79], v[116:119], v[28:31]
    ds_read_b64_tr_b16 v[72:73], v5 offset:30752
    ds_read_b64_tr_b16 v[74:75], v5 offset:33312
    v_mfma_f32_16x16x32_bf16 v[32:35], v[80:83], v[112:115], v[32:35]
    v_mfma_f32_16x16x32_bf16 v[36:39], v[80:83], v[116:119], v[36:39]
    ds_read_b64_tr_b16 v[76:77], v5 offset:30784
    ds_read_b64_tr_b16 v[78:79], v5 offset:33344
    v_mfma_f32_16x16x32_bf16 v[40:43], v[84:87], v[112:115], v[40:43]
    v_mfma_f32_16x16x32_bf16 v[44:47], v[84:87], v[116:119], v[44:47]
    ds_read_b64_tr_b16 v[80:81], v5 offset:30816
    ds_read_b64_tr_b16 v[82:83], v5 offset:33376
    ds_read_b64_tr_b16 v[84:85], v5 offset:30848
    ds_read_b64_tr_b16 v[86:87], v5 offset:33408
F_OC4:
    s_waitcnt vmcnt(6)
    v_max3_u32 v1, v120, v121, v122
    v_max3_u32 v2, v123, v124, v125
    v_max3_u32 v1, v1, v126, v127
    v_max_u32 v1, v1, v2
    v_cmp_eq_u32 vcc, -1, v1
    s_waitcnt lgkmcnt(10)
    s_cbranch_vccnz F_OR4
F_OG4:
    v_mfma_f32_16x16x32_bf16 v[8:11], v[48:51], v[120:123], v[8:11]
    v_mfma_f32_16x16x32_bf16 v[12:15], v[48:51], v[124:127], v[12:15]
    s_add_u32 s47, s59, 0
    buffer_load_dwordx2 v[152:153], v4, s[40:43], s47 offen offset:1024 sc1
    buffer_load_dwordx2 v[154:155], v4, s[40:43], s47 offen offset:2304 sc1
    buffer_load_dwordx2 v[156:157], v4, s[40:43], s47 offen offset:1152 sc1
    buffer_load_dwordx2 v[158:159], v4, s[40:43], s47 offen offset:2432 sc1
    v_mfma_f32_16x16x32_bf16 v[16:19], v[52:55], v[120:123], v[16:19]
    v_mfma_f32_16x16x32_bf16 v[20:23], v[52:55], v[124:127], v[20:23]
    ds_read_b64_tr_b16 v[48:49], v5 offset:40960
    ds_read_b64_tr_b16 v[50:51], v5 offset:43520
    v_mfma_f32_16x16x32_bf16 v[24:27], v[56:59], v[120:123], v[24:27]
    v_mfma_f32_16x16x32_bf16 v[28:31], v[56:59], v[124:127], v[28:31]
    ds_read_b64_tr_b16 v[52:53], v5 offset:40992
    ds_read_b64_tr_b16 v[54:55], v5 offset:43552
    v_mfma_f32_16x16x32_bf16 v[32:35], v[60:63], v[120:123], v[32:35]
    v_mfma_f32_16x16x32_bf16 v[36:39], v[60:63], v[124:127], v[36:39]
    ds_read_b64_tr_b16 v[56:57], v5 offset:41024
    ds_read_b64_tr_b16 v[58:59], v5 offset:43584
    v_mfma_f32_16x16x32_bf16 v[40:43], v[64:67], v[120:123], v[40:43]
    v_mfma_f32_16x16x32_bf16 v[44:47], v[64:67], v[124:127], v[44:47]
    ds_read_b64_tr_b16 v[60:61], v5 offset:41056
    ds_read_b64_tr_b16 v[62:63], v5 offset:43616
    ds_read_b64_tr_b16 v[64:65], v5 offset:41088
    ds_read_b64_tr_b16 v[66:67], v5 offset:43648
F_OC5:
    s_waitcnt vmcnt(8)
    v_max3_u32 v1, v128, v129, v130
    v_max3_u32 v2, v131, v132, v133
    v_max3_u32 v1, v1, v134, v135
    v_max_u32 v1, v1, v2
    v_cmp_eq_u32 vcc, -1, v1
    s_waitcnt lgkmcnt(10)
    s_cbranch_vccnz F_OR5
F_OG5:
    v_mfma_f32_16x16x32_bf16 v[8:11], v[68:71], v[128:131], v[8:11]
    v_mfma_f32_16x16x32_bf16 v[12:15], v[68:71], v[132:135], v[12:15]
    s_add_u32 s47, s59, 20480
    buffer_load_dwordx2 v[160:161], v4, s[40:43], s47 offen offset:1024 sc1
    buffer_load_dwordx2 v[162:163], v4, s[40:43], s47 offen offset:2304 sc1
    buffer_load_dwordx2 v[164:165], v4, s[40:43], s47 offen offset:1152 sc1
    buffer_load_dwordx2 v[166:167], v4, s[40:43], s47 offen offset:2432 sc1
    v_mfma_f32_16x16x32_bf16 v[16:19], v[72:75], v[128:131], v[16:19]
    v_mfma_f32_16x16x32_bf16 v[20:23], v[72:75], v[132:135], v[20:23]
    ds_read_b64_tr_b16 v[68:69], v5 offset:51200
    ds_read_b64_tr_b16 v[70:71], v5 offset:53760
    v_mfma_f32_16x16x32_bf16 v[24:27], v[76:79], v[128:131], v[24:27]
    v_mfma_f32_16x16x32_bf16 v[28:31], v[76:79], v[132:135], v[28:31]
    ds_read_b64_tr_b16 v[72:73], v5 offset:51232
    ds_read_b64_tr_b16 v[74:75], v5 offset:53792
    v_mfma_f32_16x16x32_bf16 v[32:35], v[80:83], v[128:131], v[32:35]
    v_mfma_f32_16x16x32_bf16 v[36:39], v[80:83], v[132:135], v[36:39]
    ds_read_b64_tr_b16 v[76:77], v5 offset:51264
    ds_read_b64_tr_b16 v[78:79], v5 offset:53824
    v_mfma_f32_16x16x32_bf16 v[40:43], v[84:87], v[128:131], v[40:43]
    v_mfma_f32_16x16x32_bf16 v[44:47], v[84:87], v[132:135], v[44:47]
    ds_read_b64_tr_b16 v[80:81], v5 offset:51296
    ds_read_b64_tr_b16 v[82:83], v5 offset:53856
    ds_read_b64_tr_b16 v[84:85], v5 offset:51328
    ds_read_b64_tr_b16 v[86:87], v5 offset:53888
    s_cmp_lg_u32 s64, 0
    s_cbranch_scc1 F_OG5A
    v_mov_b32 v3, 0
    s_mov_b32 s48, 0
F_SB24:
    ds_read_b32 v1, v3 offset:8
    s_waitcnt lgkmcnt(0)
    v_readfirstlane_b32 s47, v1
    s_add_u32 s48, s48, 1
    s_cmp_ge_u32 s48, 1048576
    s_cbranch_scc1 F_SBX25
    s_cmp_ge_u32 s47, s57
    s_cbranch_scc1 F_SBX25
    s_sleep 2
    s_branch F_SB24
F_SBX25:
    s_mul_i32 s49, s53, 5120
    s_add_u32 s49, s49, 10240
    s_mul_i32 s50, s53, 51200
    s_mov_b32 m0, s49
    s_nop 0
    buffer_load_dwordx4 v88, s[28:31], s50 offen lds
    buffer_load_dwordx4 v89, s[28:31], s50 offen offset:1024 lds
    buffer_load_dwordx4 v90, s[28:31], s50 offen offset:2048 lds
    buffer_load_dwordx4 v91, s[28:31], s50 offen offset:3072 lds
    s_add_u32 m0, s49, 4096
    s_nop 0
    buffer_load_dwordx4 v92, s[28:31], s50 offen lds
F_OG5A:
F_OC6:
    s_waitcnt vmcnt(10)
    v_max3_u32 v1, v136, v137, v138
    v_max3_u32 v2, v139, v140, v141
    v_max3_u32 v1, v1, v142, v143
    v_max_u32 v1, v1, v2
    v_cmp_eq_u32 vcc, -1, v1
    s_waitcnt lgkmcnt(10)
    s_cbranch_vccnz F_OR6
F_OG6:
    v_mfma_f32_16x16x32_bf16 v[8:11], v[48:51], v[136:139], v[8:11]
    v_mfma_f32_16x16x32_bf16 v[12:15], v[48:51], v[140:143], v[12:15]
    v_mfma_f32_16x16x32_bf16 v[16:19], v[52:55], v[136:139], v[16:19]
    v_mfma_f32_16x16x32_bf16 v[20:23], v[52:55], v[140:143], v[20:23]
    v_add_u32 v5, 61440, v5
    ds_read_b64_tr_b16 v[48:49], v5 offset:0
    ds_read_b64_tr_b16 v[50:51], v5 offset:2560
    v_mfma_f32_16x16x32_bf16 v[24:27], v[56:59], v[136:139], v[24:27]
    v_mfma_f32_16x16x32_bf16 v[28:31], v[56:59], v[140:143], v[28:31]
    ds_read_b64_tr_b16 v[52:53], v5 offset:32
    ds_read_b64_tr_b16 v[54:55], v5 offset:2592
    v_mfma_f32_16x16x32_bf16 v[32:35], v[60:63], v[136:139], v[32:35]
    v_mfma_f32_16x16x32_bf16 v[36:39], v[60:63], v[140:143], v[36:39]
    ds_read_b64_tr_b16 v[56:57], v5 offset:64
    ds_read_b64_tr_b16 v[58:59], v5 offset:2624
    v_mfma_f32_16x16x32_bf16 v[40:43], v[64:67], v[136:139], v[40:43]
    v_mfma_f32_16x16x32_bf16 v[44:47], v[64:67], v[140:143], v[44:47]
    ds_read_b64_tr_b16 v[60:61], v5 offset:96
    ds_read_b64_tr_b16 v[62:63], v5 offset:2656
    ds_read_b64_tr_b16 v[64:65], v5 offset:128
    ds_read_b64_tr_b16 v[66:67], v5 offset:2688
F_OC7:
    s_waitcnt vmcnt(8)
    v_max3_u32 v1, v144, v145, v146
    v_max3_u32 v2, v147, v148, v149
    v_max3_u32 v1, v1, v150, v151
    v_max_u32 v1, v1, v2
    v_cmp_eq_u32 vcc, -1, v1
    s_waitcnt lgkmcnt(10)
    s_cbranch_vccnz F_OR7
F_OG7:
    v_mfma_f32_16x16x32_bf16 v[8:11], v[68:71], v[144:147], v[8:11]
    v_mfma_f32_16x16x32_bf16 v[12:15], v[68:71], v[148:151], v[12:15]
    v_mfma_f32_16x16x32_bf16 v[16:19], v[72:75], v[144:147], v[16:19]
    v_mfma_f32_16x16x32_bf16 v[20:23], v[72:75], v[148:151], v[20:23]
    ds_read_b64_tr_b16 v[68:69], v5 offset:10240
    ds_read_b64_tr_b16 v[70:71], v5 offset:12800
    v_mfma_f32_16x16x32_bf16 v[24:27], v[76:79], v[144:147], v[24:27]
    v_mfma_f32_16x16x32_bf16 v[28:31], v[76:79], v[148:151], v[28:31]
    ds_read_b64_tr_b16 v[72:73], v5 offset:10272
    ds_read_b64_tr_b16 v[74:75], v5 offset:12832
    v_mfma_f32_16x16x32_bf16 v[32:35], v[80:83], v[144:147], v[32:35]
    v_mfma_f32_16x16x32_bf16 v[36:39], v[80:83], v[148:151], v[36:39]
    ds_read_b64_tr_b16 v[76:77], v5 offset:10304
    ds_read_b64_tr_b16 v[78:79], v5 offset:12864
    v_mfma_f32_16x16x32_bf16 v[40:43], v[84:87], v[144:147], v[40:43]
    v_mfma_f32_16x16x32_bf16 v[44:47], v[84:87], v[148:151], v[44:47]
    ds_read_b64_tr_b16 v[80:81], v5 offset:10336
    ds_read_b64_tr_b16 v[82:83], v5 offset:12896
    ds_read_b64_tr_b16 v[84:85], v5 offset:10368
    ds_read_b64_tr_b16 v[86:87], v5 offset:12928
F_OC8:
    s_waitcnt vmcnt(4)
    v_max3_u32 v1, v152, v153, v154
    v_max3_u32 v2, v155, v156, v157
    v_max3_u32 v1, v1, v158, v159
    v_max_u32 v1, v1, v2
    v_cmp_eq_u32 vcc, -1, v1
    s_waitcnt lgkmcnt(10)
    s_cbranch_vccnz F_OR8
F_OG8:
    v_mfma_f32_16x16x32_bf16 v[8:11], v[48:51], v[152:155], v[8:11]
    v_mfma_f32_16x16x32_bf16 v[12:15], v[48:51], v[156:159], v[12:15]
    v_mfma_f32_16x16x32_bf16 v[16:19], v[52:55], v[152:155], v[16:19]
    v_mfma_f32_16x16x32_bf16 v[20:23], v[52:55], v[156:159], v[20:23]
    v_mfma_f32_16x16x32_bf16 v[24:27], v[56:59], v[152:155], v[24:27]
    v_mfma_f32_16x16x32_bf16 v[28:31], v[56:59], v[156:159], v[28:31]
    v_mfma_f32_16x16x32_bf16 v[32:35], v[60:63], v[152:155], v[32:35]
    v_mfma_f32_16x16x32_bf16 v[36:39], v[60:63], v[156:159], v[36:39]
    v_mfma_f32_16x16x32_bf16 v[40:43], v[64:67], v[152:155], v[40:43]
    v_mfma_f32_16x16x32_bf16 v[44:47], v[64:67], v[156:159], v[44:47]
F_OC9:
    s_waitcnt vmcnt(0)
    v_max3_u32 v1, v160, v161, v162
    v_max3_u32 v2, v163, v164, v165
    v_max3_u32 v1, v1, v166, v167
    v_max_u32 v1, v1, v2
    v_cmp_eq_u32 vcc, -1, v1
    s_waitcnt lgkmcnt(0)
    s_cbranch_vccnz F_OR9
F_OG9:
    v_mfma_f32_16x16x32_bf16 v[8:11], v[68:71], v[160:163], v[8:11]
    v_mfma_f32_16x16x32_bf16 v[12:15], v[68:71], v[164:167], v[12:15]
    v_mfma_f32_16x16x32_bf16 v[16:19], v[72:75], v[160:163], v[16:19]
    v_mfma_f32_16x16x32_bf16 v[20:23], v[72:75], v[164:167], v[20:23]
    v_mfma_f32_16x16x32_bf16 v[24:27], v[76:79], v[160:163], v[24:27]
    v_mfma_f32_16x16x32_bf16 v[28:31], v[76:79], v[164:167], v[28:31]
    v_mfma_f32_16x16x32_bf16 v[32:35], v[80:83], v[160:163], v[32:35]
    v_mfma_f32_16x16x32_bf16 v[36:39], v[80:83], v[164:167], v[36:39]
    v_mfma_f32_16x16x32_bf16 v[40:43], v[84:87], v[160:163], v[40:43]
    v_mfma_f32_16x16x32_bf16 v[44:47], v[84:87], v[164:167], v[44:47]
    v_subrev_u32 v5, 61440, v5
    s_cmp_lg_u32 s64, 0
    s_cbranch_scc1 F_FIN
    v_mov_b32 v3, 0
    v_mov_b32 v2, 1
    s_mov_b64 exec, 1
    ds_add_u32 v3, v2 offset:8
    s_mov_b64 exec, -1
    s_add_u32 s57, s57, 4
    s_mov_b32 s64, 1
    s_sub_u32 s65, s65, 2621440
    s_mov_b32 s56, 71680
    s_branch F_OP
F_OR0:
    s_add_u32 s66, s66, 1
    s_cmp_ge_u32 s66, 65536
    s_cbranch_scc1 F_OG0
    s_sleep 2
    s_add_u32 s47, s58, 0
    buffer_load_dwordx4 v[88:91], v6, s[40:43], s47 offen sc1
    buffer_load_dwordx4 v[92:95], v6, s[40:43], s47 offen offset:256 sc1
    s_add_u32 s47, s58, 5120
    buffer_load_dwordx4 v[96:99], v6, s[40:43], s47 offen sc1
    buffer_load_dwordx4 v[100:103], v6, s[40:43], s47 offen offset:256 sc1
    s_add_u32 s47, s58, 10240
    buffer_load_dwordx4 v[104:107], v6, s[40:43], s47 offen sc1
    buffer_load_dwordx4 v[108:111], v6, s[40:43], s47 offen offset:256 sc1
    s_add_u32 s47, s58, 15360
    buffer_load_dwordx4 v[112:115], v6, s[40:43], s47 offen sc1
    buffer_load_dwordx4 v[116:119], v6, s[40:43], s47 offen offset:256 sc1
    s_branch F_OC0
F_OR1:
    s_add_u32 s66, s66, 1
    s_cmp_ge_u32 s66, 65536
    s_cbranch_scc1 F_OG1
    s_sleep 2
    s_add_u32 s47, s58, 5120
    buffer_load_dwordx4 v[96:99], v6, s[40:43], s47 offen sc1
    buffer_load_dwordx4 v[100:103], v6, s[40:43], s47 offen offset:256 sc1
    s_add_u32 s47, s58, 10240
    buffer_load_dwordx4 v[104:107], v6, s[40:43], s47 offen sc1
    buffer_load_dwordx4 v[108:111], v6, s[40:43], s47 offen offset:256 sc1
    s_add_u32 s47, s58, 15360
    buffer_load_dwordx4 v[112:115], v6, s[40:43], s47 offen sc1
    buffer_load_dwordx4 v[116:119], v6, s[40:43], s47 offen offset:256 sc1
    s_add_u32 s47, s58, 20480
    buffer_load_dwordx4 v[120:123], v6, s[40:43], s47 offen sc1
    buffer_load_dwordx4 v[124:127], v6, s[40:43], s47 offen offset:256 sc1
    s_branch F_OC1
F_OR2:
    s_add_u32 s66, s66, 1
    s_cmp_ge_u32 s66, 65536
    s_cbranch_scc1 F_OG2
    s_sleep 2
    s_add_u32 s47, s58, 10240
    buffer_load_dwordx4 v[104:107], v6, s[40:43], s47 offen sc1
    buffer_load_dwordx4 v[108:111], v6, s[40:43], s47 offen offset:256 sc1
    s_add_u32 s47, s58, 15360
    buffer_load_dwordx4 v[112:115], v6, s[40:43], s47 offen sc1
    buffer_load_dwordx4 v[116:119], v6, s[40:43], s47 offen offset:256 sc1
    s_add_u32 s47, s58, 20480
    buffer_load_dwordx4 v[120:123], v6, s[40:43], s47 offen sc1
    buffer_load_dwordx4 v[124:127], v6, s[40:43], s47 offen offset:256 sc1
    s_add_u32 s47, s58, 25600
    buffer_load_dwordx4 v[128:131], v6, s[40:43], s47 offen sc1
    buffer_load_dwordx4 v[132:135], v6, s[40:43], s47 offen offset:256 sc1
    s_branch F_OC2
F_OR3:
    s_add_u32 s66, s66, 1
    s_cmp_ge_u32 s66, 65536
    s_cbranch_scc1 F_OG3
    s_sleep 2
    s_add_u32 s47, s58, 15360
    buffer_load_dwordx4 v[112:115], v6, s[40:43], s47 offen sc1
    buffer_load_dwordx4 v[116:119], v6, s[40:43], s47 offen offset:256 sc1
    s_add_u32 s47, s58, 20480
    buffer_load_dwordx4 v[120:123], v6, s[40:43], s47 offen sc1
    buffer_load_dwordx4 v[124:127], v6, s[40:43], s47 offen offset:256 sc1
    s_add_u32 s47, s58, 25600
    buffer_load_dwordx4 v[128:131], v6, s[40:43], s47 offen sc1
    buffer_load_dwordx4 v[132:135], v6, s[40:43], s47 offen offset:256 sc1
    s_add_u32 s47, s58, 30720
    buffer_load_dwordx4 v[136:139], v6, s[40:43], s47 offen sc1
    buffer_load_dwordx4 v[140:143], v6, s[40:43], s47 offen offset:256 sc1
    s_branch F_OC3
F_OR4:
    s_add_u32 s66, s66, 1
    s_cmp_ge_u32 s66, 65536
    s_cbranch_scc1 F_OG4
    s_sleep 2
    s_add_u32 s47, s58, 20480
    buffer_load_dwordx4 v[120:123], v6, s[40:43], s47 offen sc1
    buffer_load_dwordx4 v[124:127], v6, s[40:43], s47 offen offset:256 sc1
    s_add_u32 s47, s58, 25600
    buffer_load_dwordx4 v[128:131], v6, s[40:43], s47 offen sc1
    buffer_load_dwordx4 v[132:135], v6, s[40:43], s47 offen offset:256 sc1
    s_add_u32 s47, s58, 30720
    buffer_load_dwordx4 v[136:139], v6, s[40:43], s47 offen sc1
    buffer_load_dwordx4 v[140:143], v6, s[40:43], s47 offen offset:256 sc1
    s_add_u32 s47, s58, 35840
    buffer_load_dwordx4 v[144:147], v6, s[40:43], s47 offen sc1
    buffer_load_dwordx4 v[148:151], v6, s[40:43], s47 offen offset:256 sc1
    s_branch F_OC4
F_OR5:
    s_add_u32 s66, s66, 1
    s_cmp_ge_u32 s66, 65536
    s_cbranch_scc1 F_OG5
    s_sleep 2
    s_add_u32 s47, s58, 25600
    buffer_load_dwordx4 v[128:131], v6, s[40:43], s47 offen sc1
    buffer_load_dwordx4 v[132:135], v6, s[40:43], s47 offen offset:256 sc1
    s_add_u32 s47, s58, 30720
    buffer_load_dwordx4 v[136:139], v6, s[40:43], s47 offen sc1
    buffer_load_dwordx4 v[140:143], v6, s[40:43], s47 offen offset:256 sc1
    s_add_u32 s47, s58, 35840
    buffer_load_dwordx4 v[144:147], v6, s[40:43], s47 offen sc1
    buffer_load_dwordx4 v[148:151], v6, s[40:43], s47 offen offset:256 sc1
    s_add_u32 s47, s59, 0
    buffer_load_dwordx2 v[152:153], v4, s[40:43], s47 offen offset:1024 sc1
    buffer_load_dwordx2 v[154:155], v4, s[40:43], s47 offen offset:2304 sc1
    buffer_load_dwordx2 v[156:157], v4, s[40:43], s47 offen offset:1152 sc1
    buffer_load_dwordx2 v[158:159], v4, s[40:43], s47 offen offset:2432 sc1
    s_branch F_OC5
F_OR6:
    s_add_u32 s66, s66, 1
    s_cmp_ge_u32 s66, 65536
    s_cbranch_scc1 F_OG6
    s_sleep 2
    s_add_u32 s47, s58, 30720
    buffer_load_dwordx4 v[136:139], v6, s[40:43], s47 offen sc1
    buffer_load_dwordx4 v[140:143], v6, s[40:43], s47 offen offset:256 sc1
    s_add_u32 s47, s58, 35840
    buffer_load_dwordx4 v[144:147], v6, s[40:43], s47 offen sc1
    buffer_load_dwordx4 v[148:151], v6, s[40:43], s47 offen offset:256 sc1
    s_add_u32 s47, s59, 0
    buffer_load_dwordx2 v[152:153], v4, s[40:43], s47 offen offset:1024 sc1
    buffer_load_dwordx2 v[154:155], v4, s[40:43], s47 offen offset:2304 sc1
    buffer_load_dwordx2 v[156:157], v4, s[40:43], s47 offen offset:1152 sc1
    buffer_load_dwordx2 v[158:159], v4, s[40:43], s47 offen offset:2432 sc1
    s_add_u32 s47, s59, 20480
    buffer_load_dwordx2 v[160:161], v4, s[40:43], s47 offen offset:1024 sc1
    buffer_load_dwordx2 v[162:163], v4, s[40:43], s47 offen offset:2304 sc1
    buffer_load_dwordx2 v[164:165], v4, s[40:43], s47 offen offset:1152 sc1
    buffer_load_dwordx2 v[166:167], v4, s[40:43], s47 offen offset:2432 sc1
    s_branch F_OC6
F_OR7:
    s_add_u32 s66, s66, 1
    s_cmp_ge_u32 s66, 65536
    s_cbranch_scc1 F_OG7
    s_sleep 2
    s_add_u32 s47, s58, 35840
    buffer_load_dwordx4 v[144:147], v6, s[40:43], s47 offen sc1
    buffer_load_dwordx4 v[148:151], v6, s[40:43], s47 offen offset:256 sc1
    s_add_u32 s47, s59, 0
    buffer_load_dwordx2 v[152:153], v4, s[40:43], s47 offen offset:1024 sc1
    buffer_load_dwordx2 v[154:155], v4, s[40:43], s47 offen offset:2304 sc1
    buffer_load_dwordx2 v[156:157], v4, s[40:43], s47 offen offset:1152 sc1
    buffer_load_dwordx2 v[158:159], v4, s[40:43], s47 offen offset:2432 sc1
    s_add_u32 s47, s59, 20480
    buffer_load_dwordx2 v[160:161], v4, s[40:43], s47 offen offset:1024 sc1
    buffer_load_dwordx2 v[162:163], v4, s[40:43], s47 offen offset:2304 sc1
    buffer_load_dwordx2 v[164:165], v4, s[40:43], s47 offen offset:1152 sc1
    buffer_load_dwordx2 v[166:167], v4, s[40:43], s47 offen offset:2432 sc1
    s_branch F_OC7
F_OR8:
    s_add_u32 s66, s66, 1
    s_cmp_ge_u32 s66, 65536
    s_cbranch_scc1 F_OG8
    s_sleep 2
    s_add_u32 s47, s59, 0
    buffer_load_dwordx2 v[152:153], v4, s[40:43], s47 offen offset:1024 sc1
    buffer_load_dwordx2 v[154:155], v4, s[40:43], s47 offen offset:2304 sc1
    buffer_load_dwordx2 v[156:157], v4, s[40:43], s47 offen offset:1152 sc1
    buffer_load_dwordx2 v[158:159], v4, s[40:43], s47 offen offset:2432 sc1
    s_add_u32 s47, s59, 20480
    buffer_load_dwordx2 v[160:161], v4, s[40:43], s47 offen offset:1024 sc1
    buffer_load_dwordx2 v[162:163], v4, s[40:43], s47 offen offset:2304 sc1
    buffer_load_dwordx2 v[164:165], v4, s[40:43], s47 offen offset:1152 sc1
    buffer_load_dwordx2 v[166:167], v4, s[40:43], s47 offen offset:2432 sc1
    s_branch F_OC8
F_OR9:
    s_add_u32 s66, s66, 1
    s_cmp_ge_u32 s66, 65536
    s_cbranch_scc1 F_OG9
    s_sleep 2
    s_add_u32 s47, s59, 20480
    buffer_load_dwordx2 v[160:161], v4, s[40:43], s47 offen offset:1024 sc1
    buffer_load_dwordx2 v[162:163], v4, s[40:43], s47 offen offset:2304 sc1
    buffer_load_dwordx2 v[164:165], v4, s[40:43], s47 offen offset:1152 sc1
    buffer_load_dwordx2 v[166:167], v4, s[40:43], s47 offen offset:2432 sc1
    s_branch F_OC9
F_FIN:
    v_add_u32 v1, s51, v7
    v_add_u32 v2, s52, v7
    v_and_b32 v3, 15, v0
    v_mul_u32_u24 v3, 2560, v3
    v_lshrrev_b32 v4, 4, v0
    v_lshl_add_u32 v3, v4, 3, v3
    s_cmp_lt_u32 s53, 2
    s_cbranch_scc1 F_FIN0
    ds_write_b128 v1, v[8:11] offset:0
    ds_write_b128 v1, v[16:19] offset:1024
    ds_write_b128 v1, v[24:27] offset:2048
    ds_write_b128 v1, v[32:35] offset:3072
    ds_write_b128 v1, v[40:43] offset:4096
    s_waitcnt lgkmcnt(0)
    s_barrier
    ds_read_b128 v[48:51], v2 offset:0
    ds_read_b128 v[52:55], v2 offset:1024
    ds_read_b128 v[56:59], v2 offset:2048
    ds_read_b128 v[60:63], v2 offset:3072
    ds_read_b128 v[64:67], v2 offset:4096
    s_waitcnt lgkmcnt(4)
    v_add_f32 v12, v12, v48
    v_add_f32 v13, v13, v49
    v_add_f32 v14, v14, v50
    v_add_f32 v15, v15, v51
    v_cvt_pk_bf16_f32 v12, v12, v13
    v_cvt_pk_bf16_f32 v13, v14, v15
    buffer_store_dwordx2 v[12:13], v3, s[32:35], s62 offen offset:0
    s_waitcnt lgkmcnt(3)
    v_add_f32 v20, v20, v52
    v_add_f32 v21, v21, v53
    v_add_f32 v22, v22, v54
    v_add_f32 v23, v23, v55
    v_cvt_pk_bf16_f32 v20, v20, v21
    v_cvt_pk_bf16_f32 v21, v22, v23
    buffer_store_dwordx2 v[20:21], v3, s[32:35], s62 offen offset:32
    s_waitcnt lgkmcnt(2)
    v_add_f32 v28, v28, v56
    v_add_f32 v29, v29, v57
    v_add_f32 v30, v30, v58
    v_add_f32 v31, v31, v59
    v_cvt_pk_bf16_f32 v28, v28, v29
    v_cvt_pk_bf16_f32 v29, v30, v31
    buffer_store_dwordx2 v[28:29], v3, s[32:35], s62 offen offset:64
    s_waitcnt lgkmcnt(1)
    v_add_f32 v36, v36, v60
    v_add_f32 v37, v37, v61
    v_add_f32 v38, v38, v62
    v_add_f32 v39, v39, v63
    v_cvt_pk_bf16_f32 v36, v36, v37
    v_cvt_pk_bf16_f32 v37, v38, v39
    buffer_store_dwordx2 v[36:37], v3, s[32:35], s62 offen offset:96
    s_waitcnt lgkmcnt(0)
    v_add_f32 v44, v44, v64
    v_add_f32 v45, v45, v65
    v_add_f32 v46, v46, v66
    v_add_f32 v47, v47, v67
    v_cvt_pk_bf16_f32 v44, v44, v45
    v_cvt_pk_bf16_f32 v45, v46, v47
    buffer_store_dwordx2 v[44:45], v3, s[32:35], s62 offen offset:128
    s_branch F_FIN1
F_FIN0:
    ds_write_b128 v1, v[12:15] offset:0
    ds_write_b128 v1, v[20:23] offset:1024
    ds_write_b128 v1, v[28:31] offset:2048
    ds_write_b128 v1, v[36:39] offset:3072
    ds_write_b128 v1, v[44:47] offset:4096
    s_waitcnt lgkmcnt(0)
    s_barrier
    ds_read_b128 v[48:51], v2 offset:0
    ds_read_b128 v[52:55], v2 offset:1024
    ds_read_b128 v[56:59], v2 offset:2048
    ds_read_b128 v[60:63], v2 offset:3072
    ds_read_b128 v[64:67], v2 offset:4096
    s_waitcnt lgkmcnt(4)
    v_add_f32 v8, v8, v48
    v_add_f32 v9, v9, v49
    v_add_f32 v10, v10, v50
    v_add_f32 v11, v11, v51
    v_cvt_pk_bf16_f32 v8, v8, v9
    v_cvt_pk_bf16_f32 v9, v10, v11
    buffer_store_dwordx2 v[8:9], v3, s[32:35], s62 offen offset:0
    s_waitcnt lgkmcnt(3)
    v_add_f32 v16, v16, v52
    v_add_f32 v17, v17, v53
    v_add_f32 v18, v18, v54
    v_add_f32 v19, v19, v55
    v_cvt_pk_bf16_f32 v16, v16, v17
    v_cvt_pk_bf16_f32 v17, v18, v19
    buffer_store_dwordx2 v[16:17], v3, s[32:35], s62 offen offset:32
    s_waitcnt lgkmcnt(2)
    v_add_f32 v24, v24, v56
    v_add_f32 v25, v25, v57
    v_add_f32 v26, v26, v58
    v_add_f32 v27, v27, v59
    v_cvt_pk_bf16_f32 v24, v24, v25
    v_cvt_pk_bf16_f32 v25, v26, v27
    buffer_store_dwordx2 v[24:25], v3, s[32:35], s62 offen offset:64
    s_waitcnt lgkmcnt(1)
    v_add_f32 v32, v32, v60
    v_add_f32 v33, v33, v61
    v_add_f32 v34, v34, v62
    v_add_f32 v35, v35, v63
    v_cvt_pk_bf16_f32 v32, v32, v33
    v_cvt_pk_bf16_f32 v33, v34, v35
    buffer_store_dwordx2 v[32:33], v3, s[32:35], s62 offen offset:96
    s_waitcnt lgkmcnt(0)
    v_add_f32 v40, v40, v64
    v_add_f32 v41, v41, v65
    v_add_f32 v42, v42, v66
    v_add_f32 v43, v43, v67
    v_cvt_pk_bf16_f32 v40, v40, v41
    v_cvt_pk_bf16_f32 v41, v42, v43
    buffer_store_dwordx2 v[40:41], v3, s[32:35], s62 offen offset:128
F_FIN1:
F_END:
    s_endpgm
.section .rodata,"a"
.p2align 6
.amdhsa_kernel gated_mix__grouped_kv_mqa__sliding_local_dilated__prompt_kernel
  .amdhsa_next_free_vgpr 168
  .amdhsa_next_free_sgpr 102
  .amdhsa_accum_offset 168
  .amdhsa_group_segment_fixed_size 0
  .amdhsa_kernarg_size 96
  .amdhsa_user_sgpr_count 2
  .amdhsa_user_sgpr_kernarg_segment_ptr 1
  .amdhsa_system_sgpr_workgroup_id_x 1
.end_amdhsa_kernel
```
